```python
import torch

def _softmax(x, axis=-1):
    return torch.softmax(x, dim=axis)
def _gelu(x):
    return torch.nn.functional.gelu(x, approximate="tanh")
def _silu(x):
    return torch.nn.functional.silu(x)
def _sigmoid(x):
    return torch.sigmoid(x)
def _layernorm(x, axis=-1, eps=1e-5):
    m = x.mean(dim=axis, keepdim=True)
    v = x.var(dim=axis, keepdim=True, unbiased=False)
    return (x - m) / torch.sqrt(v + eps)
def _scatter_add(tgt, idx, src, axis=0):
    return tgt.clone().index_add_(axis, idx, src)
def _segment_sum(src, seg, n):
    out = torch.zeros((n,) + src.shape[1:], dtype=src.dtype)
    return out.index_add_(0, seg, src)
def _pad(x, pw):
    flat = tuple(v for pair in reversed(pw) for v in pair)
    return torch.nn.functional.pad(x, flat)

kernel_name = 'standalone__dcn_v2_cross__recsys'

def setup_inputs():

    _w = (lambda a: (lambda t: t.to(torch.bfloat16) if t.is_floating_point() else t)(torch.as_tensor(a)))
    B, F, D, L = 1024, 26, 32, 6
    Din = min(F * D, 1024)
    return {
        "x0": _w((lambda *s: torch.randn(*s, dtype=torch.bfloat16) * 0.05)(B, Din)),
        "ws": _w((lambda *s: torch.randn(*s, dtype=torch.bfloat16) * 0.05)(L, Din, Din)),
        "bs": _w((lambda *s: torch.randn(*s, dtype=torch.bfloat16) * 0.05)(L, Din)),
    }

def reference(x0, ws, bs):
    x = x0
    for l in range(ws.shape[0]):
        x = x0 * (x @ ws[l] + bs[l]) + x
    return x
```

```asm
; @launch grid=(256,1,1) block=(512,1,1) lds=163840
.amdgcn_target "amdgcn-amd-amdhsa--gfx950"
.text
.globl standalone__dcn_v2_cross__recsys_kernel
.p2align 8
.type standalone__dcn_v2_cross__recsys_kernel,@function
standalone__dcn_v2_cross__recsys_kernel:
  s_cmp_ge_u32 s2, 256
  s_cbranch_scc1 L_done
  s_load_dwordx4 s[4:7], s[0:1], 0
  s_load_dwordx4 s[8:11], s[0:1], 16
  s_load_dwordx4 s[12:15], s[0:1], 32
  s_cmp_lt_u32 s2, 208
  s_cbranch_scc1 L_nocpf
  s_cmp_ge_u32 s2, 224
  s_cbranch_scc1 L_nocpf
  s_getpc_b64 s[66:67]
L_pcref:
  s_sub_u32 s66, s66, L_pcref-standalone__dcn_v2_cross__recsys_kernel
  s_subb_u32 s67, s67, 0
  s_sub_u32 s65, s2, 208
  s_lshr_b32 s65, s65, 3
  s_lshl_b32 s65, s65, 13
  v_lshlrev_b32 v3, 4, v0
  v_add_u32 v3, s65, v3
  v_cmp_gt_u32 vcc, L_codeend-standalone__dcn_v2_cross__recsys_kernel, v3
  s_and_saveexec_b64 s[68:69], vcc
  s_cbranch_execz L_cpfx
  global_load_dwordx4 v[60:63], v3, s[66:67]
L_cpfx:
  s_mov_b64 exec, s[68:69]
L_nocpf:
  s_and_b32 s43, s2, 7
  s_lshr_b32 s46, s2, 3
  v_and_b32 v1, 63, v0
  v_lshrrev_b32 v2, 6, v0
  s_getreg_b32 s50, hwreg(HW_REG_XCC_ID, 0, 4)
  v_readfirstlane_b32 s42, v2
  s_movk_i32 s70, 1664
  s_add_u32 s74, s50, 1
  s_lshl_b32 s74, s74, 4
  s_cmp_ge_u32 s46, 26
  s_cbranch_scc1 L_helper
  s_cmp_ge_u32 s46, 13
  s_cselect_b32 s47, 1, 0
  s_mul_i32 s48, s47, 13
  s_sub_u32 s41, s46, s48
  s_lshl_b32 s40, s43, 1
  s_add_u32 s40, s40, s47
  s_mov_b32 s44, 0
  s_mov_b32 s45, 0
  s_cmp_lt_u32 s42, 4
  s_cbranch_scc1 L_consumer
L_loader:
  s_sub_u32 s71, s42, 4
  v_lshrrev_b32 v3, 3, v1
  v_and_b32 v4, 7, v1
  v_lshrrev_b32 v5, 1, v3
  v_xor_b32 v6, v4, v5
  v_xor_b32 v7, 4, v6
  s_lshl_b32 s46, s71, 4
  v_add_u32 v8, s46, v3
  v_mul_lo_u32 v8, v8, s70
  v_lshlrev_b32 v6, 4, v6
  v_lshlrev_b32 v7, 4, v7
  v_add_u32 v10, v6, v8
  v_add_u32 v11, v7, v8
  v_add_u32 v11, 13312, v11
  v_and_b32 v5, 1, v5
  v_lshlrev_b32 v5, 2, v5
  v_xor_b32 v5, v4, v5
  v_lshlrev_b32 v5, 4, v5
  v_add_u32 v12, v5, v8
  v_add_u32 v13, 13312, v12
  s_mul_i32 s51, s40, 106496
  s_lshl_b32 s52, s41, 7
  s_lshl_b32 s53, s71, 11
  v_min_u32 v15, 51, v1
  s_lshl_b32 s46, s40, 7
  s_add_u32 s46, s46, 3407872
  v_add_u32 v15, s46, v15
  v_min_u32 v14, 12, v1
  s_lshl_b32 s46, s40, 4
  v_add_u32 v14, s46, v14
  s_mul_i32 s58, s43, 13
  s_lshr_b32 s58, s58, 3
  s_add_u32 s79, s41, 13
  s_sub_u32 s79, s79, s58
  s_cmp_ge_u32 s79, 13
  s_cselect_b32 s49, 13, 0
  s_sub_u32 s79, s79, s49
  s_and_b32 s81, s40, 1
  s_mul_i32 s81, s81, 13
  s_add_u32 s81, s81, s41
  s_lshl_b32 s81, s81, 2
  s_add_u32 s81, s81, s71
  s_lshl_b32 s81, s81, 6
  s_mov_b32 s80, 1384448
  s_and_b32 s101, s40, 1
  s_mul_i32 s101, s101, 3
  s_add_u32 s101, s101, s58
  s_cmp_ge_u32 s101, 13
  s_cselect_b32 s49, 13, 0
  s_sub_u32 s101, s101, s49
  s_mov_b32 s76, s52
  s_add_u32 s78, s52, 1384448
  s_waitcnt lgkmcnt(0)
  s_mov_b32 s16, s4
  s_mov_b32 s17, s5
  s_mov_b32 s18, 1703936
  s_mov_b32 s19, 0x20000
  s_mov_b32 s20, s6
  s_mov_b32 s21, s7
  s_mov_b32 s22, 8306688
  s_mov_b32 s23, 0x20000
  s_mov_b32 s24, s14
  s_mov_b32 s25, s15
  s_mov_b32 s26, 3409920
  s_mov_b32 s27, 0x20000
  s_mov_b32 s36, s12
  s_mov_b32 s37, s13
  s_mov_b32 s38, 256
  s_mov_b32 s39, 0x20000
  s_add_u32 s54, s101, 0
  s_cmp_ge_u32 s54, 13
  s_cselect_b32 s49, 13, 0
  s_sub_u32 s54, s54, s49
  s_mul_i32 s56, s54, 106496
  s_add_u32 s56, s56, s76
  s_add_u32 m0, s53, 0
  s_nop 0
  buffer_load_dwordx4 v12, s[20:23], s56 offen lds
  s_add_u32 m0, s53, 1024
  s_nop 0
  buffer_load_dwordx4 v13, s[20:23], s56 offen lds
  s_add_u32 s54, s101, 0
  s_cmp_ge_u32 s54, 13
  s_cselect_b32 s49, 13, 0
  s_sub_u32 s54, s54, s49
  s_lshl_b32 s55, s54, 7
  s_add_u32 s55, s55, s51
  s_add_u32 m0, s53, 155648
  s_nop 0
  buffer_load_dwordx4 v10, s[16:19], s55 offen lds
  s_add_u32 m0, s53, 156672
  s_nop 0
  buffer_load_dwordx4 v11, s[16:19], s55 offen lds
  s_add_u32 s54, s101, 1
  s_cmp_ge_u32 s54, 13
  s_cselect_b32 s49, 13, 0
  s_sub_u32 s54, s54, s49
  s_mul_i32 s56, s54, 106496
  s_add_u32 s56, s56, s76
  s_add_u32 m0, s53, 8192
  s_nop 0
  buffer_load_dwordx4 v12, s[20:23], s56 offen lds
  s_add_u32 m0, s53, 9216
  s_nop 0
  buffer_load_dwordx4 v13, s[20:23], s56 offen lds
  s_add_u32 s54, s101, 1
  s_cmp_ge_u32 s54, 13
  s_cselect_b32 s49, 13, 0
  s_sub_u32 s54, s54, s49
  s_lshl_b32 s55, s54, 7
  s_add_u32 s55, s55, s51
  s_add_u32 m0, s53, 106496
  s_nop 0
  buffer_load_dwordx4 v10, s[16:19], s55 offen lds
  s_add_u32 m0, s53, 107520
  s_nop 0
  buffer_load_dwordx4 v11, s[16:19], s55 offen lds
  s_add_u32 s54, s101, 2
  s_cmp_ge_u32 s54, 13
  s_cselect_b32 s49, 13, 0
  s_sub_u32 s54, s54, s49
  s_mul_i32 s56, s54, 106496
  s_add_u32 s56, s56, s76
  s_add_u32 m0, s53, 16384
  s_nop 0
  buffer_load_dwordx4 v12, s[20:23], s56 offen lds
  s_add_u32 m0, s53, 17408
  s_nop 0
  buffer_load_dwordx4 v13, s[20:23], s56 offen lds
  s_add_u32 s54, s101, 3
  s_cmp_ge_u32 s54, 13
  s_cselect_b32 s49, 13, 0
  s_sub_u32 s54, s54, s49
  s_mul_i32 s56, s54, 106496
  s_add_u32 s56, s56, s76
  s_add_u32 m0, s53, 24576
  s_nop 0
  buffer_load_dwordx4 v12, s[20:23], s56 offen lds
  s_add_u32 m0, s53, 25600
  s_nop 0
  buffer_load_dwordx4 v13, s[20:23], s56 offen lds
  s_add_u32 s54, s101, 2
  s_cmp_ge_u32 s54, 13
  s_cselect_b32 s49, 13, 0
  s_sub_u32 s54, s54, s49
  s_lshl_b32 s55, s54, 7
  s_add_u32 s55, s55, s51
  s_add_u32 m0, s53, 114688
  s_nop 0
  buffer_load_dwordx4 v10, s[16:19], s55 offen lds
  s_add_u32 m0, s53, 115712
  s_nop 0
  buffer_load_dwordx4 v11, s[16:19], s55 offen lds
  s_add_u32 s54, s101, 4
  s_cmp_ge_u32 s54, 13
  s_cselect_b32 s49, 13, 0
  s_sub_u32 s54, s54, s49
  s_mul_i32 s56, s54, 106496
  s_add_u32 s56, s56, s76
  s_add_u32 m0, s53, 32768
  s_nop 0
  buffer_load_dwordx4 v12, s[20:23], s56 offen lds
  s_add_u32 m0, s53, 33792
  s_nop 0
  buffer_load_dwordx4 v13, s[20:23], s56 offen lds
  s_add_u32 s54, s101, 5
  s_cmp_ge_u32 s54, 13
  s_cselect_b32 s49, 13, 0
  s_sub_u32 s54, s54, s49
  s_mul_i32 s56, s54, 106496
  s_add_u32 s56, s56, s76
  s_add_u32 m0, s53, 40960
  s_nop 0
  buffer_load_dwordx4 v12, s[20:23], s56 offen lds
  s_add_u32 m0, s53, 41984
  s_nop 0
  buffer_load_dwordx4 v13, s[20:23], s56 offen lds
  s_waitcnt vmcnt(12)
  s_barrier
  s_add_u32 s82, s58, 0
  s_cmp_ge_u32 s82, 13
  s_cselect_b32 s83, 13, 0
  s_sub_u32 s82, s82, s83
  s_mul_i32 s82, s82, 106496
  s_add_u32 s82, s82, s80
  s_add_u32 s82, s82, s81
  s_add_u32 s82, s6, s82
  s_addc_u32 s83, s7, 0
  s_load_dword s88, s[82:83], 0
  s_load_dword s89, s[82:83], 6656
  s_load_dword s90, s[82:83], 13312
  s_load_dword s91, s[82:83], 19968
  s_load_dword s92, s[82:83], 26624
  s_add_u32 s54, s101, 3
  s_cmp_ge_u32 s54, 13
  s_cselect_b32 s49, 13, 0
  s_sub_u32 s54, s54, s49
  s_lshl_b32 s55, s54, 7
  s_add_u32 s55, s55, s51
  s_add_u32 m0, s53, 122880
  s_nop 0
  buffer_load_dwordx4 v10, s[16:19], s55 offen lds
  s_add_u32 m0, s53, 123904
  s_nop 0
  buffer_load_dwordx4 v11, s[16:19], s55 offen lds
  s_add_u32 s54, s101, 6
  s_cmp_ge_u32 s54, 13
  s_cselect_b32 s49, 13, 0
  s_sub_u32 s54, s54, s49
  s_mul_i32 s56, s54, 106496
  s_add_u32 s56, s56, s76
  s_add_u32 m0, s53, 49152
  s_nop 0
  buffer_load_dwordx4 v12, s[20:23], s56 offen lds
  s_add_u32 m0, s53, 50176
  s_nop 0
  buffer_load_dwordx4 v13, s[20:23], s56 offen lds
  s_waitcnt vmcnt(12)
  s_barrier
  s_load_dword s93, s[82:83], 33280
  s_load_dword s94, s[82:83], 39936
  s_load_dword s95, s[82:83], 46592
  s_load_dword s96, s[82:83], 53248
  s_load_dword s97, s[82:83], 59904
  s_add_u32 s54, s101, 7
  s_cmp_ge_u32 s54, 13
  s_cselect_b32 s49, 13, 0
  s_sub_u32 s54, s54, s49
  s_mul_i32 s56, s54, 106496
  s_add_u32 s56, s56, s76
  s_add_u32 m0, s53, 57344
  s_nop 0
  buffer_load_dwordx4 v12, s[20:23], s56 offen lds
  s_add_u32 m0, s53, 58368
  s_nop 0
  buffer_load_dwordx4 v13, s[20:23], s56 offen lds
  s_add_u32 s54, s101, 4
  s_cmp_ge_u32 s54, 13
  s_cselect_b32 s49, 13, 0
  s_sub_u32 s54, s54, s49
  s_lshl_b32 s55, s54, 7
  s_add_u32 s55, s55, s51
  s_add_u32 m0, s53, 131072
  s_nop 0
  buffer_load_dwordx4 v10, s[16:19], s55 offen lds
  s_add_u32 m0, s53, 132096
  s_nop 0
  buffer_load_dwordx4 v11, s[16:19], s55 offen lds
  s_waitcnt vmcnt(12)
  s_barrier
  s_load_dword s98, s[82:83], 66560
  s_load_dword s99, s[82:83], 73216
  s_load_dword s88, s[82:83], 79872
  s_load_dword s89, s[82:83], 86528
  s_load_dword s90, s[82:83], 93184
  s_add_u32 s54, s101, 8
  s_cmp_ge_u32 s54, 13
  s_cselect_b32 s49, 13, 0
  s_sub_u32 s54, s54, s49
  s_mul_i32 s56, s54, 106496
  s_add_u32 s56, s56, s76
  s_add_u32 m0, s53, 65536
  s_nop 0
  buffer_load_dwordx4 v12, s[20:23], s56 offen lds
  s_add_u32 m0, s53, 66560
  s_nop 0
  buffer_load_dwordx4 v13, s[20:23], s56 offen lds
  s_add_u32 s54, s101, 5
  s_cmp_ge_u32 s54, 13
  s_cselect_b32 s49, 13, 0
  s_sub_u32 s54, s54, s49
  s_lshl_b32 s55, s54, 7
  s_add_u32 s55, s55, s51
  s_add_u32 m0, s53, 139264
  s_nop 0
  buffer_load_dwordx4 v10, s[16:19], s55 offen lds
  s_add_u32 m0, s53, 140288
  s_nop 0
  buffer_load_dwordx4 v11, s[16:19], s55 offen lds
  s_add_u32 s54, s101, 9
  s_cmp_ge_u32 s54, 13
  s_cselect_b32 s49, 13, 0
  s_sub_u32 s54, s54, s49
  s_mul_i32 s56, s54, 106496
  s_add_u32 s56, s56, s76
  s_add_u32 m0, s53, 73728
  s_nop 0
  buffer_load_dwordx4 v12, s[20:23], s56 offen lds
  s_add_u32 m0, s53, 74752
  s_nop 0
  buffer_load_dwordx4 v13, s[20:23], s56 offen lds
  s_waitcnt vmcnt(12)
  s_barrier
  s_load_dword s91, s[82:83], 99840
  s_add_u32 s82, s58, 1
  s_cmp_ge_u32 s82, 13
  s_cselect_b32 s83, 13, 0
  s_sub_u32 s82, s82, s83
  s_mul_i32 s82, s82, 106496
  s_add_u32 s82, s82, s80
  s_add_u32 s82, s82, s81
  s_add_u32 s82, s6, s82
  s_addc_u32 s83, s7, 0
  s_load_dword s92, s[82:83], 0
  s_load_dword s93, s[82:83], 6656
  s_load_dword s94, s[82:83], 13312
  s_load_dword s95, s[82:83], 19968
  s_add_u32 s54, s101, 7
  s_cmp_ge_u32 s54, 13
  s_cselect_b32 s49, 13, 0
  s_sub_u32 s54, s54, s49
  s_lshl_b32 s55, s54, 7
  s_add_u32 s55, s55, s51
  s_add_u32 m0, s53, 106496
  s_nop 0
  buffer_load_dwordx4 v10, s[16:19], s55 offen lds
  s_add_u32 m0, s53, 107520
  s_nop 0
  buffer_load_dwordx4 v11, s[16:19], s55 offen lds
  s_add_u32 s54, s101, 6
  s_cmp_ge_u32 s54, 13
  s_cselect_b32 s49, 13, 0
  s_sub_u32 s54, s54, s49
  s_lshl_b32 s55, s54, 7
  s_add_u32 s55, s55, s51
  s_add_u32 m0, s53, 147456
  s_nop 0
  buffer_load_dwordx4 v10, s[16:19], s55 offen lds
  s_add_u32 m0, s53, 148480
  s_nop 0
  buffer_load_dwordx4 v11, s[16:19], s55 offen lds
  s_add_u32 s54, s101, 10
  s_cmp_ge_u32 s54, 13
  s_cselect_b32 s49, 13, 0
  s_sub_u32 s54, s54, s49
  s_mul_i32 s56, s54, 106496
  s_add_u32 s56, s56, s76
  s_add_u32 m0, s53, 81920
  s_nop 0
  buffer_load_dwordx4 v12, s[20:23], s56 offen lds
  s_add_u32 m0, s53, 82944
  s_nop 0
  buffer_load_dwordx4 v13, s[20:23], s56 offen lds
  s_waitcnt vmcnt(12)
  s_barrier
  s_load_dword s96, s[82:83], 26624
  s_load_dword s97, s[82:83], 33280
  s_load_dword s98, s[82:83], 39936
  s_load_dword s99, s[82:83], 46592
  s_load_dword s88, s[82:83], 53248
  s_add_u32 s54, s101, 8
  s_cmp_ge_u32 s54, 13
  s_cselect_b32 s49, 13, 0
  s_sub_u32 s54, s54, s49
  s_lshl_b32 s55, s54, 7
  s_add_u32 s55, s55, s51
  s_add_u32 m0, s53, 114688
  s_nop 0
  buffer_load_dwordx4 v10, s[16:19], s55 offen lds
  s_add_u32 m0, s53, 115712
  s_nop 0
  buffer_load_dwordx4 v11, s[16:19], s55 offen lds
  s_add_u32 s54, s101, 11
  s_cmp_ge_u32 s54, 13
  s_cselect_b32 s49, 13, 0
  s_sub_u32 s54, s54, s49
  s_mul_i32 s56, s54, 106496
  s_add_u32 s56, s56, s76
  s_add_u32 m0, s53, 90112
  s_nop 0
  buffer_load_dwordx4 v12, s[20:23], s56 offen lds
  s_add_u32 m0, s53, 91136
  s_nop 0
  buffer_load_dwordx4 v13, s[20:23], s56 offen lds
  s_waitcnt vmcnt(12)
  s_barrier
  s_load_dword s89, s[82:83], 59904
  s_load_dword s90, s[82:83], 66560
  s_load_dword s91, s[82:83], 73216
  s_load_dword s92, s[82:83], 79872
  s_load_dword s93, s[82:83], 86528
  s_add_u32 s54, s101, 9
  s_cmp_ge_u32 s54, 13
  s_cselect_b32 s49, 13, 0
  s_sub_u32 s54, s54, s49
  s_lshl_b32 s55, s54, 7
  s_add_u32 s55, s55, s51
  s_add_u32 m0, s53, 122880
  s_nop 0
  buffer_load_dwordx4 v10, s[16:19], s55 offen lds
  s_add_u32 m0, s53, 123904
  s_nop 0
  buffer_load_dwordx4 v11, s[16:19], s55 offen lds
  s_add_u32 s54, s101, 12
  s_cmp_ge_u32 s54, 13
  s_cselect_b32 s49, 13, 0
  s_sub_u32 s54, s54, s49
  s_mul_i32 s56, s54, 106496
  s_add_u32 s56, s56, s76
  s_add_u32 m0, s53, 98304
  s_nop 0
  buffer_load_dwordx4 v12, s[20:23], s56 offen lds
  s_add_u32 m0, s53, 99328
  s_nop 0
  buffer_load_dwordx4 v13, s[20:23], s56 offen lds
  s_waitcnt vmcnt(10)
  s_barrier
  s_load_dword s94, s[82:83], 93184
  s_load_dword s95, s[82:83], 99840
  s_add_u32 s82, s58, 2
  s_cmp_ge_u32 s82, 13
  s_cselect_b32 s83, 13, 0
  s_sub_u32 s82, s82, s83
  s_mul_i32 s82, s82, 106496
  s_add_u32 s82, s82, s80
  s_add_u32 s82, s82, s81
  s_add_u32 s82, s6, s82
  s_addc_u32 s83, s7, 0
  s_load_dword s96, s[82:83], 0
  s_load_dword s97, s[82:83], 6656
  s_load_dword s98, s[82:83], 13312
  s_waitcnt vmcnt(12)
  s_barrier
  s_load_dword s99, s[82:83], 19968
  s_load_dword s88, s[82:83], 26624
  s_load_dword s89, s[82:83], 33280
  s_load_dword s90, s[82:83], 39936
  s_load_dword s91, s[82:83], 46592
  s_add_u32 s54, s101, 11
  s_cmp_ge_u32 s54, 13
  s_cselect_b32 s49, 13, 0
  s_sub_u32 s54, s54, s49
  s_lshl_b32 s55, s54, 7
  s_add_u32 s55, s55, s51
  s_add_u32 m0, s53, 139264
  s_nop 0
  buffer_load_dwordx4 v10, s[16:19], s55 offen lds
  s_add_u32 m0, s53, 140288
  s_nop 0
  buffer_load_dwordx4 v11, s[16:19], s55 offen lds
  s_add_u32 s54, s101, 10
  s_cmp_ge_u32 s54, 13
  s_cselect_b32 s49, 13, 0
  s_sub_u32 s54, s54, s49
  s_lshl_b32 s55, s54, 7
  s_add_u32 s55, s55, s51
  s_add_u32 m0, s53, 131072
  s_nop 0
  buffer_load_dwordx4 v10, s[16:19], s55 offen lds
  s_add_u32 m0, s53, 132096
  s_nop 0
  buffer_load_dwordx4 v11, s[16:19], s55 offen lds
  s_waitcnt vmcnt(10)
  s_barrier
  s_load_dword s92, s[82:83], 53248
  s_load_dword s93, s[82:83], 59904
  s_load_dword s94, s[82:83], 66560
  s_load_dword s95, s[82:83], 73216
  s_load_dword s96, s[82:83], 79872
  s_add_u32 s54, s101, 12
  s_cmp_ge_u32 s54, 13
  s_cselect_b32 s49, 13, 0
  s_sub_u32 s54, s54, s49
  s_lshl_b32 s55, s54, 7
  s_add_u32 s55, s55, s51
  s_add_u32 m0, s53, 147456
  s_nop 0
  buffer_load_dwordx4 v10, s[16:19], s55 offen lds
  s_add_u32 m0, s53, 148480
  s_nop 0
  buffer_load_dwordx4 v11, s[16:19], s55 offen lds
  s_waitcnt vmcnt(8)
  s_barrier
  s_load_dword s97, s[82:83], 86528
  s_load_dword s98, s[82:83], 93184
  s_load_dword s99, s[82:83], 99840
  s_mov_b32 s54, s41
  s_mul_i32 s56, s54, 106496
  s_add_u32 s56, s56, s78
  s_add_u32 m0, s53, 0
  s_nop 0
  buffer_load_dwordx4 v12, s[20:23], s56 offen lds
  s_add_u32 m0, s53, 1024
  s_nop 0
  buffer_load_dwordx4 v13, s[20:23], s56 offen lds
  s_waitcnt vmcnt(4)
  s_barrier
  s_cmp_ge_u32 0, s79
  s_cselect_b32 s54, 1, 0
  s_add_u32 s54, s54, s58
  s_cmp_ge_u32 s54, 13
  s_cselect_b32 s49, 13, 0
  s_sub_u32 s54, s54, s49
  s_mul_i32 s56, s54, 106496
  s_add_u32 s56, s56, s78
  s_add_u32 m0, s53, 8192
  s_nop 0
  buffer_load_dwordx4 v12, s[20:23], s56 offen lds
  s_add_u32 m0, s53, 9216
  s_nop 0
  buffer_load_dwordx4 v13, s[20:23], s56 offen lds
  s_waitcnt vmcnt(8)
  s_barrier
  s_cmp_ge_u32 1, s79
  s_cselect_b32 s54, 2, 1
  s_add_u32 s54, s54, s58
  s_cmp_ge_u32 s54, 13
  s_cselect_b32 s49, 13, 0
  s_sub_u32 s54, s54, s49
  s_mul_i32 s56, s54, 106496
  s_add_u32 s56, s56, s78
  s_add_u32 m0, s53, 16384
  s_nop 0
  buffer_load_dwordx4 v12, s[20:23], s56 offen lds
  s_add_u32 m0, s53, 17408
  s_nop 0
  buffer_load_dwordx4 v13, s[20:23], s56 offen lds
  s_waitcnt vmcnt(6)
  s_barrier
  v_mov_b32 v17, 155648
  ds_read_b32 v16, v17
  s_waitcnt lgkmcnt(0)
  s_nop 0
  v_readfirstlane_b32 s45, v16
L_lbubble:
  s_barrier
  s_cmp_eq_u32 s44, 5
  s_cbranch_scc1 L_lend
  s_cmp_ge_u32 2, s79
  s_cselect_b32 s54, 3, 2
  s_add_u32 s54, s54, s58
  s_cmp_ge_u32 s54, 13
  s_cselect_b32 s49, 13, 0
  s_sub_u32 s54, s54, s49
  s_mul_i32 s56, s54, 106496
  s_add_u32 s56, s56, s78
  s_add_u32 m0, s53, 24576
  s_nop 0
  buffer_load_dwordx4 v12, s[20:23], s56 offen lds
  s_add_u32 m0, s53, 25600
  s_nop 0
  buffer_load_dwordx4 v13, s[20:23], s56 offen lds
  s_cmp_ge_u32 3, s79
  s_cselect_b32 s54, 4, 3
  s_add_u32 s54, s54, s58
  s_cmp_ge_u32 s54, 13
  s_cselect_b32 s49, 13, 0
  s_sub_u32 s54, s54, s49
  s_mul_i32 s56, s54, 106496
  s_add_u32 s56, s56, s78
  s_add_u32 m0, s53, 32768
  s_nop 0
  buffer_load_dwordx4 v12, s[20:23], s56 offen lds
  s_add_u32 m0, s53, 33792
  s_nop 0
  buffer_load_dwordx4 v13, s[20:23], s56 offen lds
  s_cmp_ge_u32 4, s79
  s_cselect_b32 s54, 5, 4
  s_add_u32 s54, s54, s58
  s_cmp_ge_u32 s54, 13
  s_cselect_b32 s49, 13, 0
  s_sub_u32 s54, s54, s49
  s_mul_i32 s56, s54, 106496
  s_add_u32 s56, s56, s78
  s_add_u32 m0, s53, 40960
  s_nop 0
  buffer_load_dwordx4 v12, s[20:23], s56 offen lds
  s_add_u32 m0, s53, 41984
  s_nop 0
  buffer_load_dwordx4 v13, s[20:23], s56 offen lds
  s_barrier
  s_add_u32 s80, s80, 1384448
  s_min_u32 s80, s80, 6922240
  s_cmp_ge_u32 5, s79
  s_cselect_b32 s54, 6, 5
  s_add_u32 s54, s54, s58
  s_cmp_ge_u32 s54, 13
  s_cselect_b32 s49, 13, 0
  s_sub_u32 s54, s54, s49
  s_mul_i32 s56, s54, 106496
  s_add_u32 s56, s56, s78
  s_add_u32 m0, s53, 49152
  s_nop 0
  buffer_load_dwordx4 v12, s[20:23], s56 offen lds
  s_add_u32 m0, s53, 50176
  s_nop 0
  buffer_load_dwordx4 v13, s[20:23], s56 offen lds
  s_add_u32 s82, s58, 0
  s_cmp_ge_u32 s82, 13
  s_cselect_b32 s83, 13, 0
  s_sub_u32 s82, s82, s83
  s_mul_i32 s82, s82, 106496
  s_add_u32 s82, s82, s80
  s_add_u32 s82, s82, s81
  s_add_u32 s82, s6, s82
  s_addc_u32 s83, s7, 0
  s_load_dword s88, s[82:83], 0
  s_load_dword s89, s[82:83], 6656
  s_load_dword s90, s[82:83], 13312
  s_load_dword s91, s[82:83], 19968
  s_cmp_ge_u32 6, s79
  s_cselect_b32 s54, 7, 6
  s_add_u32 s54, s54, s58
  s_cmp_ge_u32 s54, 13
  s_cselect_b32 s49, 13, 0
  s_sub_u32 s54, s54, s49
  s_mul_i32 s56, s54, 106496
  s_add_u32 s56, s56, s78
  s_add_u32 m0, s53, 57344
  s_nop 0
  buffer_load_dwordx4 v12, s[20:23], s56 offen lds
  s_add_u32 m0, s53, 58368
  s_nop 0
  buffer_load_dwordx4 v13, s[20:23], s56 offen lds
  s_load_dword s92, s[82:83], 26624
  s_load_dword s93, s[82:83], 33280
  s_load_dword s94, s[82:83], 39936
  s_load_dword s95, s[82:83], 46592
  s_waitcnt vmcnt(0)
  s_cmp_eq_u32 s45, 0
  s_cbranch_scc1 L_noba
  s_barrier
L_noba:
  s_add_u32 s44, s44, 1
  s_sub_u32 s59, s44, 1
  s_and_b32 s59, s59, 1
  s_mul_i32 s59, s59, 1703936
  s_cmp_eq_u32 s45, 0
  s_cbranch_scc0 L_pslow
  buffer_load_ubyte v16, v15, s[24:27], 0 offen sc1
  s_branch L_pdone
L_pslow:
  buffer_load_ubyte v16, v14, s[36:39], 0 offen sc1
L_pdone:
  s_cmp_ge_u32 7, s79
  s_cselect_b32 s54, 8, 7
  s_add_u32 s54, s54, s58
  s_cmp_ge_u32 s54, 13
  s_cselect_b32 s49, 13, 0
  s_sub_u32 s54, s54, s49
  s_mul_i32 s56, s54, 106496
  s_add_u32 s56, s56, s78
  s_add_u32 m0, s53, 65536
  s_nop 0
  buffer_load_dwordx4 v12, s[20:23], s56 offen lds
  s_add_u32 m0, s53, 66560
  s_nop 0
  buffer_load_dwordx4 v13, s[20:23], s56 offen lds
  s_load_dword s96, s[82:83], 53248
  s_load_dword s97, s[82:83], 59904
  s_load_dword s98, s[82:83], 66560
  s_load_dword s99, s[82:83], 73216
  s_cmp_ge_u32 8, s79
  s_cselect_b32 s54, 9, 8
  s_add_u32 s54, s54, s58
  s_cmp_ge_u32 s54, 13
  s_cselect_b32 s49, 13, 0
  s_sub_u32 s54, s54, s49
  s_mul_i32 s56, s54, 106496
  s_add_u32 s56, s56, s78
  s_add_u32 m0, s53, 73728
  s_nop 0
  buffer_load_dwordx4 v12, s[20:23], s56 offen lds
  s_add_u32 m0, s53, 74752
  s_nop 0
  buffer_load_dwordx4 v13, s[20:23], s56 offen lds
  s_load_dword s88, s[82:83], 79872
  s_load_dword s89, s[82:83], 86528
  s_load_dword s90, s[82:83], 93184
  s_load_dword s91, s[82:83], 99840
  s_mov_b32 s100, s78
  s_add_u32 s78, s78, 1384448
  s_cmp_ge_u32 0, s79
  s_cselect_b32 s54, 1, 0
  s_add_u32 s54, s54, s58
  s_cmp_ge_u32 s54, 13
  s_cselect_b32 s49, 13, 0
  s_sub_u32 s54, s54, s49
  s_lshl_b32 s55, s54, 7
  s_add_u32 s55, s55, s51
  s_add_u32 s55, s55, s59
  s_add_u32 m0, s53, 106496
  s_waitcnt vmcnt(4)
  s_barrier
  v_and_b32 v17, 15, v16
  v_cmp_gt_u32 vcc, s44, v17
  s_mov_b32 s57, 0
  s_cbranch_vccz L_pollok
  s_cmp_eq_u32 s45, 0
  s_cbranch_scc0 L_rslow
  s_mov_b32 s57, 0
L_gpl:
  buffer_load_ubyte v16, v15, s[24:27], 0 offen sc1
  s_waitcnt vmcnt(0)
  v_and_b32 v17, 15, v16
  v_cmp_gt_u32 vcc, s44, v17
  s_add_u32 s57, s57, 1
  s_cmp_gt_u32 s57, 100000
  s_cbranch_scc1 L_gpxl
  s_cbranch_vccnz L_gpl
L_gpxl:
  s_branch L_pollok
L_rslow:
  s_mov_b32 s57, 0
L_gpm:
  buffer_load_ubyte v16, v14, s[36:39], 0 offen sc1
  s_waitcnt vmcnt(0)
  v_and_b32 v17, 15, v16
  v_cmp_gt_u32 vcc, s44, v17
  s_add_u32 s57, s57, 1
  s_cmp_gt_u32 s57, 100000
  s_cbranch_scc1 L_gpxm
  s_cbranch_vccnz L_gpm
L_gpxm:
L_pollok:
  s_cmp_eq_u32 s45, 0
  s_cbranch_scc1 L_noinv
  buffer_inv sc1
  s_waitcnt vmcnt(0)
L_noinv:
  buffer_load_dwordx4 v10, s[24:27], s55 offen sc1 lds
  s_add_u32 m0, s53, 107520
  s_nop 0
  buffer_load_dwordx4 v11, s[24:27], s55 offen sc1 lds
  s_cmp_ge_u32 1, s79
  s_cselect_b32 s54, 2, 1
  s_add_u32 s54, s54, s58
  s_cmp_ge_u32 s54, 13
  s_cselect_b32 s49, 13, 0
  s_sub_u32 s54, s54, s49
  s_lshl_b32 s55, s54, 7
  s_add_u32 s55, s55, s51
  s_add_u32 s55, s55, s59
  s_add_u32 m0, s53, 114688
  s_nop 0
  buffer_load_dwordx4 v10, s[24:27], s55 offen sc1 lds
  s_add_u32 m0, s53, 115712
  s_nop 0
  buffer_load_dwordx4 v11, s[24:27], s55 offen sc1 lds
  s_cmp_ge_u32 2, s79
  s_cselect_b32 s54, 3, 2
  s_add_u32 s54, s54, s58
  s_cmp_ge_u32 s54, 13
  s_cselect_b32 s49, 13, 0
  s_sub_u32 s54, s54, s49
  s_lshl_b32 s55, s54, 7
  s_add_u32 s55, s55, s51
  s_add_u32 s55, s55, s59
  s_add_u32 m0, s53, 122880
  s_nop 0
  buffer_load_dwordx4 v10, s[24:27], s55 offen sc1 lds
  s_add_u32 m0, s53, 123904
  s_nop 0
  buffer_load_dwordx4 v11, s[24:27], s55 offen sc1 lds
  s_cmp_ge_u32 3, s79
  s_cselect_b32 s54, 4, 3
  s_add_u32 s54, s54, s58
  s_cmp_ge_u32 s54, 13
  s_cselect_b32 s49, 13, 0
  s_sub_u32 s54, s54, s49
  s_lshl_b32 s55, s54, 7
  s_add_u32 s55, s55, s51
  s_add_u32 s55, s55, s59
  s_add_u32 m0, s53, 131072
  s_waitcnt vmcnt(4)
  s_barrier
  buffer_load_dwordx4 v10, s[24:27], s55 offen sc1 lds
  s_add_u32 m0, s53, 132096
  s_nop 0
  buffer_load_dwordx4 v11, s[24:27], s55 offen sc1 lds
  s_cmp_ge_u32 4, s79
  s_cselect_b32 s54, 5, 4
  s_add_u32 s54, s54, s58
  s_cmp_ge_u32 s54, 13
  s_cselect_b32 s49, 13, 0
  s_sub_u32 s54, s54, s49
  s_lshl_b32 s55, s54, 7
  s_add_u32 s55, s55, s51
  s_add_u32 s55, s55, s59
  s_add_u32 m0, s53, 139264
  s_nop 0
  buffer_load_dwordx4 v10, s[24:27], s55 offen sc1 lds
  s_add_u32 m0, s53, 140288
  s_nop 0
  buffer_load_dwordx4 v11, s[24:27], s55 offen sc1 lds
  s_cmp_ge_u32 9, s79
  s_cselect_b32 s54, 10, 9
  s_add_u32 s54, s54, s58
  s_cmp_ge_u32 s54, 13
  s_cselect_b32 s49, 13, 0
  s_sub_u32 s54, s54, s49
  s_mul_i32 s56, s54, 106496
  s_add_u32 s56, s56, s100
  s_add_u32 m0, s53, 81920
  s_nop 0
  buffer_load_dwordx4 v12, s[20:23], s56 offen lds
  s_add_u32 m0, s53, 82944
  s_nop 0
  buffer_load_dwordx4 v13, s[20:23], s56 offen lds
  s_add_u32 s82, s58, 1
  s_cmp_ge_u32 s82, 13
  s_cselect_b32 s83, 13, 0
  s_sub_u32 s82, s82, s83
  s_mul_i32 s82, s82, 106496
  s_add_u32 s82, s82, s80
  s_add_u32 s82, s82, s81
  s_add_u32 s82, s6, s82
  s_addc_u32 s83, s7, 0
  s_load_dword s92, s[82:83], 0
  s_load_dword s93, s[82:83], 6656
  s_load_dword s94, s[82:83], 13312
  s_cmp_ge_u32 5, s79
  s_cselect_b32 s54, 6, 5
  s_add_u32 s54, s54, s58
  s_cmp_ge_u32 s54, 13
  s_cselect_b32 s49, 13, 0
  s_sub_u32 s54, s54, s49
  s_lshl_b32 s55, s54, 7
  s_add_u32 s55, s55, s51
  s_add_u32 s55, s55, s59
  s_add_u32 m0, s53, 147456
  s_waitcnt vmcnt(8)
  s_barrier
  buffer_load_dwordx4 v10, s[24:27], s55 offen sc1 lds
  s_add_u32 m0, s53, 148480
  s_nop 0
  buffer_load_dwordx4 v11, s[24:27], s55 offen sc1 lds
  s_load_dword s95, s[82:83], 19968
  s_load_dword s96, s[82:83], 26624
  s_load_dword s97, s[82:83], 33280
  s_cmp_ge_u32 6, s79
  s_cselect_b32 s54, 7, 6
  s_add_u32 s54, s54, s58
  s_cmp_ge_u32 s54, 13
  s_cselect_b32 s49, 13, 0
  s_sub_u32 s54, s54, s49
  s_lshl_b32 s55, s54, 7
  s_add_u32 s55, s55, s51
  s_add_u32 s55, s55, s59
  s_add_u32 m0, s53, 106496
  s_waitcnt vmcnt(8)
  s_barrier
  buffer_load_dwordx4 v10, s[24:27], s55 offen sc1 lds
  s_add_u32 m0, s53, 107520
  s_nop 0
  buffer_load_dwordx4 v11, s[24:27], s55 offen sc1 lds
  s_cmp_ge_u32 10, s79
  s_cselect_b32 s54, 11, 10
  s_add_u32 s54, s54, s58
  s_cmp_ge_u32 s54, 13
  s_cselect_b32 s49, 13, 0
  s_sub_u32 s54, s54, s49
  s_mul_i32 s56, s54, 106496
  s_add_u32 s56, s56, s100
  s_add_u32 m0, s53, 90112
  s_nop 0
  buffer_load_dwordx4 v12, s[20:23], s56 offen lds
  s_add_u32 m0, s53, 91136
  s_nop 0
  buffer_load_dwordx4 v13, s[20:23], s56 offen lds
  s_load_dword s98, s[82:83], 39936
  s_load_dword s99, s[82:83], 46592
  s_load_dword s88, s[82:83], 53248
  s_cmp_ge_u32 7, s79
  s_cselect_b32 s54, 8, 7
  s_add_u32 s54, s54, s58
  s_cmp_ge_u32 s54, 13
  s_cselect_b32 s49, 13, 0
  s_sub_u32 s54, s54, s49
  s_lshl_b32 s55, s54, 7
  s_add_u32 s55, s55, s51
  s_add_u32 s55, s55, s59
  s_add_u32 m0, s53, 114688
  s_waitcnt vmcnt(10)
  s_barrier
  buffer_load_dwordx4 v10, s[24:27], s55 offen sc1 lds
  s_add_u32 m0, s53, 115712
  s_nop 0
  buffer_load_dwordx4 v11, s[24:27], s55 offen sc1 lds
  s_load_dword s89, s[82:83], 59904
  s_load_dword s90, s[82:83], 66560
  s_load_dword s91, s[82:83], 73216
  s_cmp_ge_u32 8, s79
  s_cselect_b32 s54, 9, 8
  s_add_u32 s54, s54, s58
  s_cmp_ge_u32 s54, 13
  s_cselect_b32 s49, 13, 0
  s_sub_u32 s54, s54, s49
  s_lshl_b32 s55, s54, 7
  s_add_u32 s55, s55, s51
  s_add_u32 s55, s55, s59
  s_add_u32 m0, s53, 122880
  s_waitcnt vmcnt(10)
  s_barrier
  buffer_load_dwordx4 v10, s[24:27], s55 offen sc1 lds
  s_add_u32 m0, s53, 123904
  s_nop 0
  buffer_load_dwordx4 v11, s[24:27], s55 offen sc1 lds
  s_cmp_ge_u32 11, s79
  s_cselect_b32 s54, 12, 11
  s_add_u32 s54, s54, s58
  s_cmp_ge_u32 s54, 13
  s_cselect_b32 s49, 13, 0
  s_sub_u32 s54, s54, s49
  s_mul_i32 s56, s54, 106496
  s_add_u32 s56, s56, s100
  s_add_u32 m0, s53, 98304
  s_nop 0
  buffer_load_dwordx4 v12, s[20:23], s56 offen lds
  s_add_u32 m0, s53, 99328
  s_nop 0
  buffer_load_dwordx4 v13, s[20:23], s56 offen lds
  s_load_dword s92, s[82:83], 79872
  s_load_dword s93, s[82:83], 86528
  s_load_dword s94, s[82:83], 93184
  s_cmp_ge_u32 9, s79
  s_cselect_b32 s54, 10, 9
  s_add_u32 s54, s54, s58
  s_cmp_ge_u32 s54, 13
  s_cselect_b32 s49, 13, 0
  s_sub_u32 s54, s54, s49
  s_lshl_b32 s55, s54, 7
  s_add_u32 s55, s55, s51
  s_add_u32 s55, s55, s59
  s_add_u32 m0, s53, 131072
  s_waitcnt vmcnt(10)
  s_barrier
  buffer_load_dwordx4 v10, s[24:27], s55 offen sc1 lds
  s_add_u32 m0, s53, 132096
  s_nop 0
  buffer_load_dwordx4 v11, s[24:27], s55 offen sc1 lds
  s_load_dword s95, s[82:83], 99840
  s_add_u32 s82, s58, 2
  s_cmp_ge_u32 s82, 13
  s_cselect_b32 s83, 13, 0
  s_sub_u32 s82, s82, s83
  s_mul_i32 s82, s82, 106496
  s_add_u32 s82, s82, s80
  s_add_u32 s82, s82, s81
  s_add_u32 s82, s6, s82
  s_addc_u32 s83, s7, 0
  s_load_dword s96, s[82:83], 0
  s_load_dword s97, s[82:83], 6656
  s_cmp_ge_u32 10, s79
  s_cselect_b32 s54, 11, 10
  s_add_u32 s54, s54, s58
  s_cmp_ge_u32 s54, 13
  s_cselect_b32 s49, 13, 0
  s_sub_u32 s54, s54, s49
  s_lshl_b32 s55, s54, 7
  s_add_u32 s55, s55, s51
  s_add_u32 s55, s55, s59
  s_add_u32 m0, s53, 139264
  s_waitcnt vmcnt(10)
  s_barrier
  buffer_load_dwordx4 v10, s[24:27], s55 offen sc1 lds
  s_add_u32 m0, s53, 140288
  s_nop 0
  buffer_load_dwordx4 v11, s[24:27], s55 offen sc1 lds
  s_load_dword s98, s[82:83], 13312
  s_load_dword s99, s[82:83], 19968
  s_load_dword s88, s[82:83], 26624
  s_cmp_ge_u32 11, s79
  s_cselect_b32 s54, 12, 11
  s_add_u32 s54, s54, s58
  s_cmp_ge_u32 s54, 13
  s_cselect_b32 s49, 13, 0
  s_sub_u32 s54, s54, s49
  s_lshl_b32 s55, s54, 7
  s_add_u32 s55, s55, s51
  s_add_u32 s55, s55, s59
  s_add_u32 m0, s53, 147456
  s_waitcnt vmcnt(8)
  s_barrier
  buffer_load_dwordx4 v10, s[24:27], s55 offen sc1 lds
  s_add_u32 m0, s53, 148480
  s_nop 0
  buffer_load_dwordx4 v11, s[24:27], s55 offen sc1 lds
  s_load_dword s89, s[82:83], 33280
  s_load_dword s90, s[82:83], 39936
  s_load_dword s91, s[82:83], 46592
  s_mov_b32 s54, s41
  s_mul_i32 s56, s54, 106496
  s_add_u32 s56, s56, s78
  s_add_u32 m0, s53, 0
  s_waitcnt vmcnt(8)
  s_barrier
  s_cmp_eq_u32 s44, 5
  s_cbranch_scc1 L_skw9
  buffer_load_dwordx4 v12, s[20:23], s56 offen lds
  s_add_u32 m0, s53, 1024
  s_nop 0
  buffer_load_dwordx4 v13, s[20:23], s56 offen lds
L_skw9:
  s_load_dword s92, s[82:83], 53248
  s_load_dword s93, s[82:83], 59904
  s_load_dword s94, s[82:83], 66560
  s_load_dword s95, s[82:83], 73216
  s_load_dword s96, s[82:83], 79872
  s_load_dword s97, s[82:83], 86528
  s_load_dword s98, s[82:83], 93184
  s_load_dword s99, s[82:83], 99840
  s_cmp_ge_u32 0, s79
  s_cselect_b32 s54, 1, 0
  s_add_u32 s54, s54, s58
  s_cmp_ge_u32 s54, 13
  s_cselect_b32 s49, 13, 0
  s_sub_u32 s54, s54, s49
  s_mul_i32 s56, s54, 106496
  s_add_u32 s56, s56, s78
  s_add_u32 m0, s53, 8192
  s_cmp_eq_u32 s44, 5
  s_cbranch_scc1 L_wa10
  s_waitcnt vmcnt(6)
  s_branch L_wb10
L_wa10:
  s_waitcnt vmcnt(4)
L_wb10:
  s_barrier
  s_cmp_eq_u32 s44, 5
  s_cbranch_scc1 L_skw10
  buffer_load_dwordx4 v12, s[20:23], s56 offen lds
  s_add_u32 m0, s53, 9216
  s_nop 0
  buffer_load_dwordx4 v13, s[20:23], s56 offen lds
L_skw10:
  s_cmp_ge_u32 1, s79
  s_cselect_b32 s54, 2, 1
  s_add_u32 s54, s54, s58
  s_cmp_ge_u32 s54, 13
  s_cselect_b32 s49, 13, 0
  s_sub_u32 s54, s54, s49
  s_mul_i32 s56, s54, 106496
  s_add_u32 s56, s56, s78
  s_add_u32 m0, s53, 16384
  s_cmp_eq_u32 s44, 5
  s_cbranch_scc1 L_wa11
  s_waitcnt vmcnt(6)
  s_branch L_wb11
L_wa11:
  s_waitcnt vmcnt(2)
L_wb11:
  s_barrier
  s_cmp_eq_u32 s44, 5
  s_cbranch_scc1 L_skw11
  buffer_load_dwordx4 v12, s[20:23], s56 offen lds
  s_add_u32 m0, s53, 17408
  s_nop 0
  buffer_load_dwordx4 v13, s[20:23], s56 offen lds
L_skw11:
  s_cmp_eq_u32 s44, 5
  s_cbranch_scc1 L_wa12
  s_waitcnt vmcnt(6)
  s_branch L_wb12
L_wa12:
  s_waitcnt vmcnt(0)
L_wb12:
  s_barrier
  s_branch L_lbubble
L_lend:
  s_branch L_done
L_consumer:
  s_lshr_b32 s71, s42, 1
  s_and_b32 s72, s42, 1
  v_and_b32 v3, 31, v1
  v_lshrrev_b32 v4, 5, v1
  s_lshl_b32 s46, s40, 6
  s_lshl_b32 s47, s71, 5
  s_add_u32 s46, s46, s47
  v_add_u32 v5, s46, v3
  v_mul_lo_u32 v5, v5, s70
  s_lshl_b32 s47, s41, 7
  s_lshl_b32 s48, s72, 6
  s_add_u32 s47, s47, s48
  v_lshlrev_b32 v6, 5, v4
  v_add_u32 v191, s47, v6
  v_add_u32 v190, v5, v191
  s_waitcnt lgkmcnt(0)
  s_mov_b32 s16, s4
  s_mov_b32 s17, s5
  s_mov_b32 s18, 1703936
  s_mov_b32 s19, 0x20000
  s_mov_b32 s24, s14
  s_mov_b32 s25, s15
  s_mov_b32 s26, 3409920
  s_mov_b32 s27, 0x20000
  s_mov_b32 s28, s10
  s_mov_b32 s29, s11
  s_mov_b32 s30, 1703936
  s_mov_b32 s31, 0x20000
  s_mov_b32 s32, s8
  s_mov_b32 s33, s9
  s_mov_b32 s34, 9984
  s_mov_b32 s35, 0x20000
  s_mov_b32 s36, s12
  s_mov_b32 s37, s13
  s_mov_b32 s38, 256
  s_mov_b32 s39, 0x20000
  buffer_load_dwordx4 v[168:171], v190, s[16:19], 0 offen
  buffer_load_dwordx4 v[172:175], v190, s[16:19], 0 offen offset:16
  v_min_u32 v195, 12, v1
  s_lshl_b32 s49, s40, 4
  v_add_u32 v195, s49, v195
  buffer_load_ubyte v176, v195, s[36:39], 0 offen
  v_lshrrev_b32 v5, 2, v1
  v_add_u32 v6, s46, v5
  v_mul_lo_u32 v6, v6, s70
  v_and_b32 v7, 3, v1
  v_lshlrev_b32 v8, 4, v7
  v_add_u32 v6, v6, v8
  v_add_u32 v194, s47, v6
  s_lshl_b32 s48, s71, 5
  v_add_u32 v5, s48, v5
  v_lshrrev_b32 v6, 1, v5
  v_and_b32 v6, 7, v6
  s_lshl_b32 s49, s72, 2
  v_add_u32 v7, s49, v7
  v_xor_b32 v6, v6, v7
  v_lshlrev_b32 v6, 4, v6
  v_lshlrev_b32 v5, 7, v5
  v_add_u32 v5, v5, v6
  v_add_u32 v193, 155648, v5
  v_add_u32 v5, s48, v3
  v_lshrrev_b32 v6, 1, v5
  v_and_b32 v6, 7, v6
  v_xor_b32 v7, v6, v4
  v_lshlrev_b32 v7, 4, v7
  v_lshlrev_b32 v8, 7, v5
  v_add_u32 v7, v7, v8
  v_add_u32 v184, 106496, v7
  v_xor_b32 v185, 32, v184
  v_xor_b32 v186, 64, v184
  v_xor_b32 v187, 96, v184
  v_lshlrev_b32 v7, 1, v4
  v_add_u32 v7, s49, v7
  v_xor_b32 v7, v7, v6
  v_lshlrev_b32 v7, 4, v7
  v_add_u32 v7, v7, v8
  v_add_u32 v192, 155648, v7
  v_xor_b32 v196, 16, v192
  v_lshrrev_b32 v5, 4, v1
  v_lshrrev_b32 v6, 2, v1
  v_and_b32 v6, 3, v6
  v_and_b32 v7, 3, v1
  v_and_b32 v8, 1, v5
  v_lshrrev_b32 v5, 1, v5
  v_and_b32 v10, 1, v7
  v_lshlrev_b32 v10, 1, v10
  v_add_u32 v10, v10, v8
  v_add_u32 v10, s49, v10
  v_lshrrev_b32 v11, 1, v6
  v_lshlrev_b32 v11, 2, v11
  v_xor_b32 v10, v10, v11
  v_lshlrev_b32 v10, 4, v10
  v_lshrrev_b32 v11, 1, v7
  v_lshlrev_b32 v11, 3, v11
  v_add_u32 v10, v10, v11
  v_lshlrev_b32 v5, 3, v5
  v_add_u32 v5, v5, v6
  v_lshlrev_b32 v5, 7, v5
  v_add_u32 v188, v10, v5
  v_add_u32 v189, 0x10000, v188
  s_mov_b32 s73, 0xffff0000
  s_cmp_eq_u32 s42, 0
  s_cbranch_scc0 L_noann
  s_lshl_b32 s46, s40, 4
  s_add_u32 s46, s46, s41
  v_mov_b32 v10, s46
  v_mov_b32 v11, s74
  s_lshl_b32 s46, s40, 7
  s_add_u32 s46, s46, 3407872
  s_lshl_b32 s47, s41, 2
  s_add_u32 s47, s46, s47
  v_mov_b32 v12, s47
  s_add_u32 s46, s46, 64
  v_mov_b32 v13, s46
  v_mov_b32 v14, 0
  s_mov_b64 s[68:69], exec
  s_mov_b64 exec, 1
  buffer_store_dword v14, v12, s[24:27], 0 offen sc1
  s_cmp_eq_u32 s41, 0
  s_cbranch_scc0 L_nozh
  buffer_store_byte v14, v13, s[24:27], 0 offen sc1
L_nozh:
  s_mov_b64 exec, s[68:69]
L_noann:
L_clayer:
  s_mul_i32 s46, s44, 1664
  buffer_load_dwordx4 v[160:163], v191, s[32:35], s46 offen
  buffer_load_dwordx4 v[164:167], v191, s[32:35], s46 offen offset:16
  v_mov_b32 v16, 0
  v_mov_b32 v17, 0
  v_mov_b32 v18, 0
  v_mov_b32 v19, 0
  v_mov_b32 v20, 0
  v_mov_b32 v21, 0
  v_mov_b32 v22, 0
  v_mov_b32 v23, 0
  v_mov_b32 v24, 0
  v_mov_b32 v25, 0
  v_mov_b32 v26, 0
  v_mov_b32 v27, 0
  v_mov_b32 v28, 0
  v_mov_b32 v29, 0
  v_mov_b32 v30, 0
  v_mov_b32 v31, 0
  s_barrier
  ds_read_b128 v[32:35], v184 offset:49152
  ds_read_b128 v[36:39], v185 offset:49152
  ds_read_b128 v[40:43], v186 offset:49152
  ds_read_b128 v[44:47], v187 offset:49152
  ds_read_b64_tr_b16 v[64:65], v188 offset:0
  ds_read_b64_tr_b16 v[66:67], v188 offset:512
  ds_read_b64_tr_b16 v[68:69], v188 offset:2048
  ds_read_b64_tr_b16 v[70:71], v188 offset:2560
  ds_read_b64_tr_b16 v[72:73], v188 offset:4096
  ds_read_b64_tr_b16 v[74:75], v188 offset:4608
  ds_read_b64_tr_b16 v[76:77], v188 offset:6144
  ds_read_b64_tr_b16 v[78:79], v188 offset:6656
  ds_read_b64_tr_b16 v[80:81], v188 offset:8192
  ds_read_b64_tr_b16 v[82:83], v188 offset:8704
  ds_read_b64_tr_b16 v[84:85], v188 offset:10240
  ds_read_b64_tr_b16 v[86:87], v188 offset:10752
  ds_read_b64_tr_b16 v[88:89], v188 offset:12288
  ds_read_b64_tr_b16 v[90:91], v188 offset:12800
  ds_read_b64_tr_b16 v[92:93], v188 offset:14336
  ds_read_b64_tr_b16 v[94:95], v188 offset:14848
  s_barrier
  s_waitcnt lgkmcnt(8)
  v_mfma_f32_32x32x16_bf16 v[16:31], v[64:67], v[32:35], v[16:31]
  ds_read_b128 v[48:51], v184 offset:0
  ds_read_b128 v[52:55], v185 offset:0
  ds_read_b128 v[56:59], v186 offset:0
  v_mfma_f32_32x32x16_bf16 v[16:31], v[68:71], v[36:39], v[16:31]
  ds_read_b128 v[60:63], v187 offset:0
  ds_read_b64_tr_b16 v[96:97], v188 offset:16384
  ds_read_b64_tr_b16 v[98:99], v188 offset:16896
  v_mfma_f32_32x32x16_bf16 v[16:31], v[72:75], v[40:43], v[16:31]
  ds_read_b64_tr_b16 v[100:101], v188 offset:18432
  ds_read_b64_tr_b16 v[102:103], v188 offset:18944
  ds_read_b64_tr_b16 v[104:105], v188 offset:20480
  v_mfma_f32_32x32x16_bf16 v[16:31], v[76:79], v[44:47], v[16:31]
  ds_read_b64_tr_b16 v[106:107], v188 offset:20992
  ds_read_b64_tr_b16 v[108:109], v188 offset:22528
  ds_read_b64_tr_b16 v[110:111], v188 offset:23040
  s_barrier
  s_waitcnt lgkmcnt(8)
  v_mfma_f32_32x32x16_bf16 v[16:31], v[80:83], v[48:51], v[16:31]
  ds_read_b128 v[32:35], v184 offset:8192
  ds_read_b128 v[36:39], v185 offset:8192
  ds_read_b128 v[40:43], v186 offset:8192
  v_mfma_f32_32x32x16_bf16 v[16:31], v[84:87], v[52:55], v[16:31]
  ds_read_b128 v[44:47], v187 offset:8192
  ds_read_b64_tr_b16 v[64:65], v188 offset:24576
  ds_read_b64_tr_b16 v[66:67], v188 offset:25088
  v_mfma_f32_32x32x16_bf16 v[16:31], v[88:91], v[56:59], v[16:31]
  ds_read_b64_tr_b16 v[68:69], v188 offset:26624
  ds_read_b64_tr_b16 v[70:71], v188 offset:27136
  ds_read_b64_tr_b16 v[72:73], v188 offset:28672
  v_mfma_f32_32x32x16_bf16 v[16:31], v[92:95], v[60:63], v[16:31]
  ds_read_b64_tr_b16 v[74:75], v188 offset:29184
  ds_read_b64_tr_b16 v[76:77], v188 offset:30720
  ds_read_b64_tr_b16 v[78:79], v188 offset:31232
  s_or_b32 s46, s44, s42
  s_cmp_eq_u32 s46, 0
  s_cbranch_scc0 L_noann2
  s_lshl_b32 s46, s40, 4
  s_add_u32 s46, s46, s41
  v_mov_b32 v10, s46
  v_mov_b32 v11, s74
  s_waitcnt vmcnt(0)
  s_mov_b64 s[68:69], exec
  s_mov_b64 exec, 1
  buffer_store_byte v11, v10, s[36:39], 0 offen
  s_mov_b64 exec, s[68:69]
L_noann2:
  s_barrier
  s_waitcnt lgkmcnt(8)
  v_mfma_f32_32x32x16_bf16 v[16:31], v[96:99], v[32:35], v[16:31]
  ds_read_b128 v[48:51], v184 offset:16384
  ds_read_b128 v[52:55], v185 offset:16384
  ds_read_b128 v[56:59], v186 offset:16384
  v_mfma_f32_32x32x16_bf16 v[16:31], v[100:103], v[36:39], v[16:31]
  ds_read_b128 v[60:63], v187 offset:16384
  ds_read_b64_tr_b16 v[80:81], v188 offset:32768
  ds_read_b64_tr_b16 v[82:83], v188 offset:33280
  v_mfma_f32_32x32x16_bf16 v[16:31], v[104:107], v[40:43], v[16:31]
  ds_read_b64_tr_b16 v[84:85], v188 offset:34816
  ds_read_b64_tr_b16 v[86:87], v188 offset:35328
  ds_read_b64_tr_b16 v[88:89], v188 offset:36864
  v_mfma_f32_32x32x16_bf16 v[16:31], v[108:111], v[44:47], v[16:31]
  ds_read_b64_tr_b16 v[90:91], v188 offset:37376
  ds_read_b64_tr_b16 v[92:93], v188 offset:38912
  ds_read_b64_tr_b16 v[94:95], v188 offset:39424
  s_barrier
  s_waitcnt lgkmcnt(8)
  v_mfma_f32_32x32x16_bf16 v[16:31], v[64:67], v[48:51], v[16:31]
  ds_read_b128 v[32:35], v184 offset:24576
  ds_read_b128 v[36:39], v185 offset:24576
  ds_read_b128 v[40:43], v186 offset:24576
  v_mfma_f32_32x32x16_bf16 v[16:31], v[68:71], v[52:55], v[16:31]
  ds_read_b128 v[44:47], v187 offset:24576
  ds_read_b64_tr_b16 v[96:97], v188 offset:40960
  ds_read_b64_tr_b16 v[98:99], v188 offset:41472
  v_mfma_f32_32x32x16_bf16 v[16:31], v[72:75], v[56:59], v[16:31]
  ds_read_b64_tr_b16 v[100:101], v188 offset:43008
  ds_read_b64_tr_b16 v[102:103], v188 offset:43520
  ds_read_b64_tr_b16 v[104:105], v188 offset:45056
  v_mfma_f32_32x32x16_bf16 v[16:31], v[76:79], v[60:63], v[16:31]
  ds_read_b64_tr_b16 v[106:107], v188 offset:45568
  ds_read_b64_tr_b16 v[108:109], v188 offset:47104
  ds_read_b64_tr_b16 v[110:111], v188 offset:47616
  s_barrier
  s_waitcnt lgkmcnt(8)
  v_mfma_f32_32x32x16_bf16 v[16:31], v[80:83], v[32:35], v[16:31]
  ds_read_b128 v[48:51], v184 offset:32768
  ds_read_b128 v[52:55], v185 offset:32768
  ds_read_b128 v[56:59], v186 offset:32768
  v_mfma_f32_32x32x16_bf16 v[16:31], v[84:87], v[36:39], v[16:31]
  ds_read_b128 v[60:63], v187 offset:32768
  ds_read_b64_tr_b16 v[64:65], v188 offset:49152
  ds_read_b64_tr_b16 v[66:67], v188 offset:49664
  v_mfma_f32_32x32x16_bf16 v[16:31], v[88:91], v[40:43], v[16:31]
  ds_read_b64_tr_b16 v[68:69], v188 offset:51200
  ds_read_b64_tr_b16 v[70:71], v188 offset:51712
  ds_read_b64_tr_b16 v[72:73], v188 offset:53248
  v_mfma_f32_32x32x16_bf16 v[16:31], v[92:95], v[44:47], v[16:31]
  ds_read_b64_tr_b16 v[74:75], v188 offset:53760
  ds_read_b64_tr_b16 v[76:77], v188 offset:55296
  ds_read_b64_tr_b16 v[78:79], v188 offset:55808
  s_barrier
  s_waitcnt lgkmcnt(8)
  v_mfma_f32_32x32x16_bf16 v[16:31], v[96:99], v[48:51], v[16:31]
  ds_read_b128 v[32:35], v184 offset:40960
  ds_read_b128 v[36:39], v185 offset:40960
  ds_read_b128 v[40:43], v186 offset:40960
  v_mfma_f32_32x32x16_bf16 v[16:31], v[100:103], v[52:55], v[16:31]
  ds_read_b128 v[44:47], v187 offset:40960
  ds_read_b64_tr_b16 v[80:81], v188 offset:57344
  ds_read_b64_tr_b16 v[82:83], v188 offset:57856
  v_mfma_f32_32x32x16_bf16 v[16:31], v[104:107], v[56:59], v[16:31]
  ds_read_b64_tr_b16 v[84:85], v188 offset:59392
  ds_read_b64_tr_b16 v[86:87], v188 offset:59904
  ds_read_b64_tr_b16 v[88:89], v188 offset:61440
  v_mfma_f32_32x32x16_bf16 v[16:31], v[108:111], v[60:63], v[16:31]
  ds_read_b64_tr_b16 v[90:91], v188 offset:61952
  ds_read_b64_tr_b16 v[92:93], v188 offset:63488
  ds_read_b64_tr_b16 v[94:95], v188 offset:64000
  s_barrier
  s_waitcnt lgkmcnt(8)
  v_mfma_f32_32x32x16_bf16 v[16:31], v[64:67], v[32:35], v[16:31]
  ds_read_b128 v[48:51], v184 offset:0
  ds_read_b128 v[52:55], v185 offset:0
  ds_read_b128 v[56:59], v186 offset:0
  v_mfma_f32_32x32x16_bf16 v[16:31], v[68:71], v[36:39], v[16:31]
  ds_read_b128 v[60:63], v187 offset:0
  ds_read_b64_tr_b16 v[96:97], v189 offset:0
  ds_read_b64_tr_b16 v[98:99], v189 offset:512
  v_mfma_f32_32x32x16_bf16 v[16:31], v[72:75], v[40:43], v[16:31]
  ds_read_b64_tr_b16 v[100:101], v189 offset:2048
  ds_read_b64_tr_b16 v[102:103], v189 offset:2560
  ds_read_b64_tr_b16 v[104:105], v189 offset:4096
  v_mfma_f32_32x32x16_bf16 v[16:31], v[76:79], v[44:47], v[16:31]
  ds_read_b64_tr_b16 v[106:107], v189 offset:4608
  ds_read_b64_tr_b16 v[108:109], v189 offset:6144
  ds_read_b64_tr_b16 v[110:111], v189 offset:6656
  s_barrier
  s_waitcnt lgkmcnt(8)
  v_mfma_f32_32x32x16_bf16 v[16:31], v[80:83], v[48:51], v[16:31]
  ds_read_b128 v[32:35], v184 offset:8192
  ds_read_b128 v[36:39], v185 offset:8192
  ds_read_b128 v[40:43], v186 offset:8192
  v_mfma_f32_32x32x16_bf16 v[16:31], v[84:87], v[52:55], v[16:31]
  ds_read_b128 v[44:47], v187 offset:8192
  ds_read_b64_tr_b16 v[64:65], v189 offset:8192
  ds_read_b64_tr_b16 v[66:67], v189 offset:8704
  v_mfma_f32_32x32x16_bf16 v[16:31], v[88:91], v[56:59], v[16:31]
  ds_read_b64_tr_b16 v[68:69], v189 offset:10240
  ds_read_b64_tr_b16 v[70:71], v189 offset:10752
  ds_read_b64_tr_b16 v[72:73], v189 offset:12288
  v_mfma_f32_32x32x16_bf16 v[16:31], v[92:95], v[60:63], v[16:31]
  ds_read_b64_tr_b16 v[74:75], v189 offset:12800
  ds_read_b64_tr_b16 v[76:77], v189 offset:14336
  ds_read_b64_tr_b16 v[78:79], v189 offset:14848
  s_waitcnt vmcnt(0)
  v_lshlrev_b32 v144, 16, v160
  v_and_b32 v145, s73, v160
  v_lshlrev_b32 v146, 16, v161
  v_and_b32 v147, s73, v161
  v_lshlrev_b32 v148, 16, v162
  v_and_b32 v149, s73, v162
  v_lshlrev_b32 v150, 16, v163
  v_and_b32 v151, s73, v163
  v_lshlrev_b32 v152, 16, v164
  v_and_b32 v153, s73, v164
  v_lshlrev_b32 v154, 16, v165
  v_and_b32 v155, s73, v165
  v_lshlrev_b32 v156, 16, v166
  v_and_b32 v157, s73, v166
  v_lshlrev_b32 v158, 16, v167
  v_and_b32 v159, s73, v167
  s_cmp_eq_u32 s44, 0
  s_cbranch_scc0 L_cnot0
  v_lshlrev_b32 v112, 16, v168
  v_and_b32 v113, s73, v168
  v_lshlrev_b32 v114, 16, v169
  v_and_b32 v115, s73, v169
  v_lshlrev_b32 v116, 16, v170
  v_and_b32 v117, s73, v170
  v_lshlrev_b32 v118, 16, v171
  v_and_b32 v119, s73, v171
  v_lshlrev_b32 v120, 16, v172
  v_and_b32 v121, s73, v172
  v_lshlrev_b32 v122, 16, v173
  v_and_b32 v123, s73, v173
  v_lshlrev_b32 v124, 16, v174
  v_and_b32 v125, s73, v174
  v_lshlrev_b32 v126, 16, v175
  v_and_b32 v127, s73, v175
  v_mov_b32 v128, v112
  v_mov_b32 v129, v113
  v_mov_b32 v130, v114
  v_mov_b32 v131, v115
  v_mov_b32 v132, v116
  v_mov_b32 v133, v117
  v_mov_b32 v134, v118
  v_mov_b32 v135, v119
  v_mov_b32 v136, v120
  v_mov_b32 v137, v121
  v_mov_b32 v138, v122
  v_mov_b32 v139, v123
  v_mov_b32 v140, v124
  v_mov_b32 v141, v125
  v_mov_b32 v142, v126
  v_mov_b32 v143, v127
  s_mov_b32 s57, 0
L_gpc:
  buffer_load_ubyte v176, v195, s[36:39], 0 offen sc1
  s_waitcnt vmcnt(0)
  v_cmp_eq_u32 vcc, 0, v176
  s_add_u32 s57, s57, 1
  s_cmp_gt_u32 s57, 12000
  s_cbranch_scc1 L_gpxc
  s_cbranch_vccnz L_gpc
L_gpxc:
  v_and_b32 v177, 0xf0, v176
  v_cmp_ne_u32 vcc, s74, v177
  s_nop 4
  s_cmp_eq_u64 vcc, 0
  s_cselect_b32 s45, 0, 1
  s_lshl_b32 s46, s40, 7
  s_add_u32 s46, s46, 3407872
  v_mov_b32 v178, s46
  buffer_load_dword v179, v178, s[24:27], 0 offen sc1
  s_waitcnt vmcnt(0)
  v_mov_b32 v176, s45
  v_mov_b32 v177, 155648
  ds_write_b32 v177, v176
  s_waitcnt lgkmcnt(0)
L_cnot0:
  s_barrier
  s_waitcnt lgkmcnt(8)
  v_mfma_f32_32x32x16_bf16 v[16:31], v[96:99], v[32:35], v[16:31]
  ds_read_b128 v[48:51], v184 offset:16384
  ds_read_b128 v[52:55], v185 offset:16384
  ds_read_b128 v[56:59], v186 offset:16384
  v_mfma_f32_32x32x16_bf16 v[16:31], v[100:103], v[36:39], v[16:31]
  ds_read_b128 v[60:63], v187 offset:16384
  ds_read_b64_tr_b16 v[80:81], v189 offset:16384
  ds_read_b64_tr_b16 v[82:83], v189 offset:16896
  v_mfma_f32_32x32x16_bf16 v[16:31], v[104:107], v[40:43], v[16:31]
  ds_read_b64_tr_b16 v[84:85], v189 offset:18432
  ds_read_b64_tr_b16 v[86:87], v189 offset:18944
  ds_read_b64_tr_b16 v[88:89], v189 offset:20480
  v_mfma_f32_32x32x16_bf16 v[16:31], v[108:111], v[44:47], v[16:31]
  ds_read_b64_tr_b16 v[90:91], v189 offset:20992
  ds_read_b64_tr_b16 v[92:93], v189 offset:22528
  ds_read_b64_tr_b16 v[94:95], v189 offset:23040
  s_barrier
  s_waitcnt lgkmcnt(8)
  v_mfma_f32_32x32x16_bf16 v[16:31], v[64:67], v[48:51], v[16:31]
  ds_read_b128 v[32:35], v184 offset:24576
  ds_read_b128 v[36:39], v185 offset:24576
  ds_read_b128 v[40:43], v186 offset:24576
  v_mfma_f32_32x32x16_bf16 v[16:31], v[68:71], v[52:55], v[16:31]
  ds_read_b128 v[44:47], v187 offset:24576
  ds_read_b64_tr_b16 v[96:97], v189 offset:24576
  ds_read_b64_tr_b16 v[98:99], v189 offset:25088
  v_mfma_f32_32x32x16_bf16 v[16:31], v[72:75], v[56:59], v[16:31]
  ds_read_b64_tr_b16 v[100:101], v189 offset:26624
  ds_read_b64_tr_b16 v[102:103], v189 offset:27136
  ds_read_b64_tr_b16 v[104:105], v189 offset:28672
  v_mfma_f32_32x32x16_bf16 v[16:31], v[76:79], v[60:63], v[16:31]
  ds_read_b64_tr_b16 v[106:107], v189 offset:29184
  ds_read_b64_tr_b16 v[108:109], v189 offset:30720
  ds_read_b64_tr_b16 v[110:111], v189 offset:31232
  s_barrier
  s_waitcnt lgkmcnt(8)
  v_mfma_f32_32x32x16_bf16 v[16:31], v[80:83], v[32:35], v[16:31]
  ds_read_b128 v[48:51], v184 offset:32768
  ds_read_b128 v[52:55], v185 offset:32768
  ds_read_b128 v[56:59], v186 offset:32768
  v_mfma_f32_32x32x16_bf16 v[16:31], v[84:87], v[36:39], v[16:31]
  ds_read_b128 v[60:63], v187 offset:32768
  ds_read_b64_tr_b16 v[64:65], v189 offset:32768
  ds_read_b64_tr_b16 v[66:67], v189 offset:33280
  v_mfma_f32_32x32x16_bf16 v[16:31], v[88:91], v[40:43], v[16:31]
  ds_read_b64_tr_b16 v[68:69], v189 offset:34816
  ds_read_b64_tr_b16 v[70:71], v189 offset:35328
  ds_read_b64_tr_b16 v[72:73], v189 offset:36864
  v_mfma_f32_32x32x16_bf16 v[16:31], v[92:95], v[44:47], v[16:31]
  ds_read_b64_tr_b16 v[74:75], v189 offset:37376
  ds_read_b64_tr_b16 v[76:77], v189 offset:38912
  ds_read_b64_tr_b16 v[78:79], v189 offset:39424
  s_barrier
  s_waitcnt lgkmcnt(8)
  v_mfma_f32_32x32x16_bf16 v[16:31], v[96:99], v[48:51], v[16:31]
  ds_read_b128 v[32:35], v184 offset:40960
  ds_read_b128 v[36:39], v185 offset:40960
  ds_read_b128 v[40:43], v186 offset:40960
  v_mfma_f32_32x32x16_bf16 v[16:31], v[100:103], v[52:55], v[16:31]
  ds_read_b128 v[44:47], v187 offset:40960
  v_mfma_f32_32x32x16_bf16 v[16:31], v[104:107], v[56:59], v[16:31]
  v_mfma_f32_32x32x16_bf16 v[16:31], v[108:111], v[60:63], v[16:31]
  s_waitcnt lgkmcnt(0)
  v_mfma_f32_32x32x16_bf16 v[16:31], v[64:67], v[32:35], v[16:31]
  s_barrier
  v_mfma_f32_32x32x16_bf16 v[16:31], v[68:71], v[36:39], v[16:31]
  v_mfma_f32_32x32x16_bf16 v[16:31], v[72:75], v[40:43], v[16:31]
  v_mfma_f32_32x32x16_bf16 v[16:31], v[76:79], v[44:47], v[16:31]
  s_and_b32 s46, s44, 1
  s_mul_i32 s46, s46, 1703936
  s_add_u32 s47, s46, 26624
  s_nop 12
  v_mov_b32 v176, v16
  v_cvt_pk_bf16_f32 v16, 0, v16
  v_cvt_pk_bf16_f32 v17, 0, v17
  v_cvt_pk_bf16_f32 v18, 0, v18
  v_cvt_pk_bf16_f32 v19, 0, v19
  v_cvt_pk_bf16_f32 v20, 0, v20
  v_cvt_pk_bf16_f32 v21, 0, v21
  v_cvt_pk_bf16_f32 v22, 0, v22
  v_cvt_pk_bf16_f32 v23, 0, v23
  v_cvt_pk_bf16_f32 v24, 0, v24
  v_cvt_pk_bf16_f32 v25, 0, v25
  v_cvt_pk_bf16_f32 v26, 0, v26
  v_cvt_pk_bf16_f32 v27, 0, v27
  v_cvt_pk_bf16_f32 v28, 0, v28
  v_cvt_pk_bf16_f32 v29, 0, v29
  v_cvt_pk_bf16_f32 v30, 0, v30
  v_cvt_pk_bf16_f32 v31, 0, v31
  v_pk_add_f32 v[16:17], v[16:17], v[144:145]
  v_pk_add_f32 v[18:19], v[18:19], v[146:147]
  v_pk_add_f32 v[20:21], v[20:21], v[148:149]
  v_pk_add_f32 v[22:23], v[22:23], v[150:151]
  v_pk_add_f32 v[24:25], v[24:25], v[152:153]
  v_pk_add_f32 v[26:27], v[26:27], v[154:155]
  v_pk_add_f32 v[28:29], v[28:29], v[156:157]
  v_pk_add_f32 v[30:31], v[30:31], v[158:159]
  v_cvt_pk_bf16_f32 v16, 0, v16
  v_cvt_pk_bf16_f32 v17, 0, v17
  v_cvt_pk_bf16_f32 v18, 0, v18
  v_cvt_pk_bf16_f32 v19, 0, v19
  v_cvt_pk_bf16_f32 v20, 0, v20
  v_cvt_pk_bf16_f32 v21, 0, v21
  v_cvt_pk_bf16_f32 v22, 0, v22
  v_cvt_pk_bf16_f32 v23, 0, v23
  v_cvt_pk_bf16_f32 v24, 0, v24
  v_cvt_pk_bf16_f32 v25, 0, v25
  v_cvt_pk_bf16_f32 v26, 0, v26
  v_cvt_pk_bf16_f32 v27, 0, v27
  v_cvt_pk_bf16_f32 v28, 0, v28
  v_cvt_pk_bf16_f32 v29, 0, v29
  v_cvt_pk_bf16_f32 v30, 0, v30
  v_cvt_pk_bf16_f32 v31, 0, v31
  v_pk_mul_f32 v[16:17], v[16:17], v[112:113]
  v_pk_mul_f32 v[18:19], v[18:19], v[114:115]
  v_pk_mul_f32 v[20:21], v[20:21], v[116:117]
  v_pk_mul_f32 v[22:23], v[22:23], v[118:119]
  v_pk_mul_f32 v[24:25], v[24:25], v[120:121]
  v_pk_mul_f32 v[26:27], v[26:27], v[122:123]
  v_pk_mul_f32 v[28:29], v[28:29], v[124:125]
  v_pk_mul_f32 v[30:31], v[30:31], v[126:127]
  v_cvt_pk_bf16_f32 v16, 0, v16
  v_cvt_pk_bf16_f32 v17, 0, v17
  v_cvt_pk_bf16_f32 v18, 0, v18
  v_cvt_pk_bf16_f32 v19, 0, v19
  v_cvt_pk_bf16_f32 v20, 0, v20
  v_cvt_pk_bf16_f32 v21, 0, v21
  v_cvt_pk_bf16_f32 v22, 0, v22
  v_cvt_pk_bf16_f32 v23, 0, v23
  v_cvt_pk_bf16_f32 v24, 0, v24
  v_cvt_pk_bf16_f32 v25, 0, v25
  v_cvt_pk_bf16_f32 v26, 0, v26
  v_cvt_pk_bf16_f32 v27, 0, v27
  v_cvt_pk_bf16_f32 v28, 0, v28
  v_cvt_pk_bf16_f32 v29, 0, v29
  v_cvt_pk_bf16_f32 v30, 0, v30
  v_cvt_pk_bf16_f32 v31, 0, v31
  v_pk_add_f32 v[16:17], v[16:17], v[128:129]
  v_pk_add_f32 v[18:19], v[18:19], v[130:131]
  v_pk_add_f32 v[20:21], v[20:21], v[132:133]
  v_pk_add_f32 v[22:23], v[22:23], v[134:135]
  v_pk_add_f32 v[24:25], v[24:25], v[136:137]
  v_pk_add_f32 v[26:27], v[26:27], v[138:139]
  v_pk_add_f32 v[28:29], v[28:29], v[140:141]
  v_pk_add_f32 v[30:31], v[30:31], v[142:143]
  v_cvt_pk_bf16_f32 v168, v16, v17
  v_cvt_pk_bf16_f32 v169, v18, v19
  v_cvt_pk_bf16_f32 v170, v20, v21
  v_cvt_pk_bf16_f32 v171, v22, v23
  v_cvt_pk_bf16_f32 v172, v24, v25
  v_cvt_pk_bf16_f32 v173, v26, v27
  v_cvt_pk_bf16_f32 v174, v28, v29
  v_cvt_pk_bf16_f32 v175, v30, v31
  ds_write_b128 v192, v[168:171]
  ds_write_b128 v196, v[172:175]
  ds_read_b128 v[176:179], v193
  ds_read_b128 v[180:183], v193 offset:2048
  s_cmp_eq_u32 s44, 5
  s_cbranch_scc1 L_final
  s_waitcnt lgkmcnt(1)
  buffer_store_dwordx4 v[176:179], v194, s[24:27], s46 offen
  s_waitcnt lgkmcnt(0)
  buffer_store_dwordx4 v[180:183], v194, s[24:27], s47 offen
  s_barrier
  s_or_b32 s46, s42, s41
  s_cmp_eq_u32 s46, 0
  s_cbranch_scc0 L_nohint1
  s_lshl_b32 s46, s40, 7
  s_add_u32 s46, s46, 3407936
  v_mov_b32 v12, s46
  s_add_u32 s47, s44, 1
  v_mov_b32 v13, s47
  s_mov_b64 s[68:69], exec
  s_mov_b64 exec, 1
  buffer_store_byte v13, v12, s[24:27], 0 offen
  s_mov_b64 exec, s[68:69]
L_nohint1:
  v_lshlrev_b32 v128, 16, v168
  v_and_b32 v129, s73, v168
  v_lshlrev_b32 v130, 16, v169
  v_and_b32 v131, s73, v169
  v_lshlrev_b32 v132, 16, v170
  v_and_b32 v133, s73, v170
  v_lshlrev_b32 v134, 16, v171
  v_and_b32 v135, s73, v171
  v_lshlrev_b32 v136, 16, v172
  v_and_b32 v137, s73, v172
  v_lshlrev_b32 v138, 16, v173
  v_and_b32 v139, s73, v173
  v_lshlrev_b32 v140, 16, v174
  v_and_b32 v141, s73, v174
  v_lshlrev_b32 v142, 16, v175
  v_and_b32 v143, s73, v175
  s_add_u32 s44, s44, 1
  s_or_b32 s48, s74, s44
  v_mov_b32 v10, s48
  s_lshl_b32 s46, s40, 7
  s_lshl_b32 s47, s41, 2
  s_add_u32 s46, s46, s47
  s_add_u32 s46, s46, s42
  s_add_u32 s46, s46, 3407872
  v_mov_b32 v14, s46
  s_cmp_eq_u32 s45, 0
  s_cbranch_scc0 L_cslow
  s_waitcnt vmcnt(0)
  s_mov_b64 s[68:69], exec
  s_mov_b64 exec, 1
  buffer_store_byte v10, v14, s[24:27], 0 offen
  s_mov_b64 exec, s[68:69]
  s_branch L_cflagged
L_cslow:
  s_lshl_b32 s46, s40, 4
  s_add_u32 s46, s46, s41
  v_mov_b32 v11, s46
  s_waitcnt vmcnt(0)
  buffer_wbl2 sc1
  s_waitcnt vmcnt(0)
  s_barrier
  s_cmp_eq_u32 s42, 0
  s_cbranch_scc0 L_cflagged
  s_mov_b64 s[68:69], exec
  s_mov_b64 exec, 1
  buffer_store_byte v10, v11, s[36:39], 0 offen sc1
  s_mov_b64 exec, s[68:69]
L_cflagged:
  s_branch L_clayer
L_final:
  s_waitcnt lgkmcnt(1)
  buffer_store_dwordx4 v[176:179], v194, s[28:31], 0 offen
  s_movk_i32 s47, 26624
  s_waitcnt lgkmcnt(0)
  buffer_store_dwordx4 v[180:183], v194, s[28:31], s47 offen
  s_branch L_done
L_helper:
  s_waitcnt lgkmcnt(0)
  s_mov_b32 s16, s4
  s_mov_b32 s17, s5
  s_mov_b32 s18, 1703936
  s_mov_b32 s19, 0x20000
  s_mov_b32 s20, s6
  s_mov_b32 s21, s7
  s_mov_b32 s22, 8306688
  s_mov_b32 s23, 0x20000
  s_mov_b32 s24, s14
  s_mov_b32 s25, s15
  s_mov_b32 s26, 3409920
  s_mov_b32 s27, 0x20000
  s_mov_b32 s32, s8
  s_mov_b32 s33, s9
  s_mov_b32 s34, 9984
  s_mov_b32 s35, 0x20000
  s_mov_b32 s36, s12
  s_mov_b32 s37, s13
  s_mov_b32 s38, 256
  s_mov_b32 s39, 0x20000
  s_sub_u32 s71, s46, 26
  s_lshl_b32 s71, s71, 3
  s_add_u32 s72, s71, s42
  v_lshlrev_b32 v11, 4, v1
  v_lshrrev_b32 v3, 3, v1
  v_and_b32 v4, 7, v1
  v_mul_lo_u32 v3, v3, s70
  v_lshlrev_b32 v4, 4, v4
  v_add_u32 v10, v3, v4
  s_mul_i32 s75, s43, 13
  s_lshr_b32 s75, s75, 3
  s_mul_i32 s76, s43, 169
  s_add_u32 s71, s76, 169
  s_lshr_b32 s76, s76, 3
  s_lshr_b32 s71, s71, 3
  s_sub_u32 s71, s71, s76
  v_min_u32 v14, 12, v1
  s_lshl_b32 s47, s43, 5
  v_add_u32 v14, s47, v14
  s_lshl_b32 s47, s43, 8
  s_add_u32 s47, s47, 3407936
  v_mov_b32 v15, s47
  s_cmp_eq_u32 s42, 7
  s_cbranch_scc1 L_pacer
  s_sub_u32 s72, s46, 26
  s_mul_i32 s72, s72, 7
  s_add_u32 s72, s72, s42
  s_lshl_b32 s78, s72, 10
  buffer_load_dwordx4 v[40:43], v11, s[32:35], s78 offen
  s_mul_i32 s78, s43, 212992
  s_lshl_b32 s77, s72, 10
  s_add_u32 s78, s78, s77
  buffer_load_dwordx4 v[20:23], v11, s[16:19], s78 offen
  s_add_u32 s78, s78, 43008
  buffer_load_dwordx4 v[24:27], v11, s[16:19], s78 offen
  s_add_u32 s78, s78, 43008
  buffer_load_dwordx4 v[28:31], v11, s[16:19], s78 offen
  s_add_u32 s78, s78, 43008
  buffer_load_dwordx4 v[32:35], v11, s[16:19], s78 offen
  s_add_u32 s78, s78, 43008
  s_cmp_lt_u32 s72, 40
  s_cbranch_scc0 L_hs0
  buffer_load_dwordx4 v[20:23], v11, s[16:19], s78 offen
L_hs0:
  s_waitcnt vmcnt(10)
  s_mul_i32 s78, s43, 212992
  s_lshl_b32 s77, s72, 10
  s_add_u32 s78, s78, s77
  buffer_load_dwordx4 v[20:23], v11, s[24:27], s78 offen
  s_add_u32 s78, s78, 43008
  buffer_load_dwordx4 v[24:27], v11, s[24:27], s78 offen
  s_add_u32 s78, s78, 43008
  buffer_load_dwordx4 v[28:31], v11, s[24:27], s78 offen
  s_add_u32 s78, s78, 43008
  buffer_load_dwordx4 v[32:35], v11, s[24:27], s78 offen
  s_add_u32 s78, s78, 43008
  s_cmp_lt_u32 s72, 40
  s_cbranch_scc0 L_hs1
  buffer_load_dwordx4 v[20:23], v11, s[24:27], s78 offen
L_hs1:
  s_waitcnt vmcnt(10)
  s_lshl_b32 s78, s72, 10
  s_add_u32 s78, s78, 1664
  s_cmp_lt_u32 s72, 2
  s_cbranch_scc0 L_nb1
  buffer_load_dwordx4 v[44:47], v11, s[32:35], s78 offen
L_nb1:
  s_add_u32 s73, s75, 3
  s_cmp_ge_u32 s73, 13
  s_cselect_b32 s77, 13, 0
  s_sub_u32 s73, s73, s77
  s_mul_i32 s78, s73, 106496
  s_add_u32 s78, s78, 1384448
  s_lshl_b32 s77, s72, 10
  s_add_u32 s78, s78, s77
  buffer_load_dwordx4 v[20:23], v11, s[20:23], s78 offen
  s_add_u32 s78, s78, 43008
  buffer_load_dwordx4 v[24:27], v11, s[20:23], s78 offen
  s_add_u32 s78, s78, 43008
  s_cmp_lt_u32 s72, 20
  s_cbranch_scc0 L_hs2
  buffer_load_dwordx4 v[28:31], v11, s[20:23], s78 offen
L_hs2:
  s_waitcnt vmcnt(10)
  s_add_u32 s73, s75, 4
  s_cmp_ge_u32 s73, 13
  s_cselect_b32 s77, 13, 0
  s_sub_u32 s73, s73, s77
  s_mul_i32 s78, s73, 106496
  s_add_u32 s78, s78, 1384448
  s_lshl_b32 s77, s72, 10
  s_add_u32 s78, s78, s77
  buffer_load_dwordx4 v[20:23], v11, s[20:23], s78 offen
  s_add_u32 s78, s78, 43008
  buffer_load_dwordx4 v[24:27], v11, s[20:23], s78 offen
  s_add_u32 s78, s78, 43008
  s_cmp_lt_u32 s72, 20
  s_cbranch_scc0 L_hs3
  buffer_load_dwordx4 v[28:31], v11, s[20:23], s78 offen
L_hs3:
  s_waitcnt vmcnt(10)
  s_add_u32 s73, s75, 5
  s_cmp_ge_u32 s73, 13
  s_cselect_b32 s77, 13, 0
  s_sub_u32 s73, s73, s77
  s_mul_i32 s78, s73, 106496
  s_add_u32 s78, s78, 1384448
  s_lshl_b32 s77, s72, 10
  s_add_u32 s78, s78, s77
  buffer_load_dwordx4 v[20:23], v11, s[20:23], s78 offen
  s_add_u32 s78, s78, 43008
  buffer_load_dwordx4 v[24:27], v11, s[20:23], s78 offen
  s_add_u32 s78, s78, 43008
  s_cmp_lt_u32 s72, 20
  s_cbranch_scc0 L_hs4
  buffer_load_dwordx4 v[28:31], v11, s[20:23], s78 offen
L_hs4:
  s_waitcnt vmcnt(10)
  s_add_u32 s73, s75, 6
  s_cmp_ge_u32 s73, 13
  s_cselect_b32 s77, 13, 0
  s_sub_u32 s73, s73, s77
  s_mul_i32 s78, s73, 106496
  s_add_u32 s78, s78, 1384448
  s_lshl_b32 s77, s72, 10
  s_add_u32 s78, s78, s77
  buffer_load_dwordx4 v[20:23], v11, s[20:23], s78 offen
  s_add_u32 s78, s78, 43008
  buffer_load_dwordx4 v[24:27], v11, s[20:23], s78 offen
  s_add_u32 s78, s78, 43008
  s_cmp_lt_u32 s72, 20
  s_cbranch_scc0 L_hs5
  buffer_load_dwordx4 v[28:31], v11, s[20:23], s78 offen
L_hs5:
  s_waitcnt vmcnt(10)
  s_add_u32 s73, s75, 7
  s_cmp_ge_u32 s73, 13
  s_cselect_b32 s77, 13, 0
  s_sub_u32 s73, s73, s77
  s_mul_i32 s78, s73, 106496
  s_add_u32 s78, s78, 1384448
  s_lshl_b32 s77, s72, 10
  s_add_u32 s78, s78, s77
  buffer_load_dwordx4 v[20:23], v11, s[20:23], s78 offen
  s_add_u32 s78, s78, 43008
  buffer_load_dwordx4 v[24:27], v11, s[20:23], s78 offen
  s_add_u32 s78, s78, 43008
  s_cmp_lt_u32 s72, 20
  s_cbranch_scc0 L_hs6
  buffer_load_dwordx4 v[28:31], v11, s[20:23], s78 offen
L_hs6:
  s_waitcnt vmcnt(10)
  s_add_u32 s73, s75, 8
  s_cmp_ge_u32 s73, 13
  s_cselect_b32 s77, 13, 0
  s_sub_u32 s73, s73, s77
  s_mul_i32 s78, s73, 106496
  s_add_u32 s78, s78, 1384448
  s_lshl_b32 s77, s72, 10
  s_add_u32 s78, s78, s77
  buffer_load_dwordx4 v[20:23], v11, s[20:23], s78 offen
  s_add_u32 s78, s78, 43008
  buffer_load_dwordx4 v[24:27], v11, s[20:23], s78 offen
  s_add_u32 s78, s78, 43008
  s_cmp_lt_u32 s72, 20
  s_cbranch_scc0 L_hs7
  buffer_load_dwordx4 v[28:31], v11, s[20:23], s78 offen
L_hs7:
  s_waitcnt vmcnt(10)
  s_add_u32 s73, s75, 9
  s_cmp_ge_u32 s73, 13
  s_cselect_b32 s77, 13, 0
  s_sub_u32 s73, s73, s77
  s_mul_i32 s78, s73, 106496
  s_add_u32 s78, s78, 1384448
  s_lshl_b32 s77, s72, 10
  s_add_u32 s78, s78, s77
  buffer_load_dwordx4 v[20:23], v11, s[20:23], s78 offen
  s_add_u32 s78, s78, 43008
  buffer_load_dwordx4 v[24:27], v11, s[20:23], s78 offen
  s_add_u32 s78, s78, 43008
  s_cmp_lt_u32 s72, 20
  s_cbranch_scc0 L_hs8
  buffer_load_dwordx4 v[28:31], v11, s[20:23], s78 offen
L_hs8:
  s_waitcnt vmcnt(10)
  s_add_u32 s73, s75, 10
  s_cmp_ge_u32 s73, 13
  s_cselect_b32 s77, 13, 0
  s_sub_u32 s73, s73, s77
  s_mul_i32 s78, s73, 106496
  s_add_u32 s78, s78, 1384448
  s_lshl_b32 s77, s72, 10
  s_add_u32 s78, s78, s77
  buffer_load_dwordx4 v[20:23], v11, s[20:23], s78 offen
  s_add_u32 s78, s78, 43008
  buffer_load_dwordx4 v[24:27], v11, s[20:23], s78 offen
  s_add_u32 s78, s78, 43008
  s_cmp_lt_u32 s72, 20
  s_cbranch_scc0 L_hs9
  buffer_load_dwordx4 v[28:31], v11, s[20:23], s78 offen
L_hs9:
  s_waitcnt vmcnt(10)
  s_add_u32 s73, s75, 11
  s_cmp_ge_u32 s73, 13
  s_cselect_b32 s77, 13, 0
  s_sub_u32 s73, s73, s77
  s_mul_i32 s78, s73, 106496
  s_add_u32 s78, s78, 1384448
  s_lshl_b32 s77, s72, 10
  s_add_u32 s78, s78, s77
  buffer_load_dwordx4 v[20:23], v11, s[20:23], s78 offen
  s_add_u32 s78, s78, 43008
  buffer_load_dwordx4 v[24:27], v11, s[20:23], s78 offen
  s_add_u32 s78, s78, 43008
  s_cmp_lt_u32 s72, 20
  s_cbranch_scc0 L_hs10
  buffer_load_dwordx4 v[28:31], v11, s[20:23], s78 offen
L_hs10:
  s_waitcnt vmcnt(10)
  s_add_u32 s73, s75, 12
  s_cmp_ge_u32 s73, 13
  s_cselect_b32 s77, 13, 0
  s_sub_u32 s73, s73, s77
  s_mul_i32 s78, s73, 106496
  s_add_u32 s78, s78, 1384448
  s_lshl_b32 s77, s72, 10
  s_add_u32 s78, s78, s77
  buffer_load_dwordx4 v[20:23], v11, s[20:23], s78 offen
  s_add_u32 s78, s78, 43008
  buffer_load_dwordx4 v[24:27], v11, s[20:23], s78 offen
  s_add_u32 s78, s78, 43008
  s_cmp_lt_u32 s72, 20
  s_cbranch_scc0 L_hs11
  buffer_load_dwordx4 v[28:31], v11, s[20:23], s78 offen
L_hs11:
  s_waitcnt vmcnt(10)
  s_mul_i32 s78, s43, 212992
  s_add_u32 s78, s78, 1703936
  s_lshl_b32 s77, s72, 10
  s_add_u32 s78, s78, s77
  buffer_load_dwordx4 v[20:23], v11, s[24:27], s78 offen
  s_add_u32 s78, s78, 43008
  buffer_load_dwordx4 v[24:27], v11, s[24:27], s78 offen
  s_add_u32 s78, s78, 43008
  buffer_load_dwordx4 v[28:31], v11, s[24:27], s78 offen
  s_add_u32 s78, s78, 43008
  buffer_load_dwordx4 v[32:35], v11, s[24:27], s78 offen
  s_add_u32 s78, s78, 43008
  s_cmp_lt_u32 s72, 40
  s_cbranch_scc0 L_hs12
  buffer_load_dwordx4 v[20:23], v11, s[24:27], s78 offen
L_hs12:
  s_waitcnt vmcnt(10)
  s_barrier
  s_lshl_b32 s78, s72, 10
  s_add_u32 s78, s78, 3328
  s_cmp_lt_u32 s72, 2
  s_cbranch_scc0 L_nb2
  buffer_load_dwordx4 v[44:47], v11, s[32:35], s78 offen
L_nb2:
  s_add_u32 s73, s75, 3
  s_cmp_ge_u32 s73, 13
  s_cselect_b32 s77, 13, 0
  s_sub_u32 s73, s73, s77
  s_mul_i32 s78, s73, 106496
  s_add_u32 s78, s78, 2768896
  s_lshl_b32 s77, s72, 10
  s_add_u32 s78, s78, s77
  buffer_load_dwordx4 v[20:23], v11, s[20:23], s78 offen
  s_add_u32 s78, s78, 43008
  buffer_load_dwordx4 v[24:27], v11, s[20:23], s78 offen
  s_add_u32 s78, s78, 43008
  s_cmp_lt_u32 s72, 20
  s_cbranch_scc0 L_hs13
  buffer_load_dwordx4 v[28:31], v11, s[20:23], s78 offen
L_hs13:
  s_waitcnt vmcnt(10)
  s_add_u32 s73, s75, 4
  s_cmp_ge_u32 s73, 13
  s_cselect_b32 s77, 13, 0
  s_sub_u32 s73, s73, s77
  s_mul_i32 s78, s73, 106496
  s_add_u32 s78, s78, 2768896
  s_lshl_b32 s77, s72, 10
  s_add_u32 s78, s78, s77
  buffer_load_dwordx4 v[20:23], v11, s[20:23], s78 offen
  s_add_u32 s78, s78, 43008
  buffer_load_dwordx4 v[24:27], v11, s[20:23], s78 offen
  s_add_u32 s78, s78, 43008
  s_cmp_lt_u32 s72, 20
  s_cbranch_scc0 L_hs14
  buffer_load_dwordx4 v[28:31], v11, s[20:23], s78 offen
L_hs14:
  s_waitcnt vmcnt(10)
  s_add_u32 s73, s75, 5
  s_cmp_ge_u32 s73, 13
  s_cselect_b32 s77, 13, 0
  s_sub_u32 s73, s73, s77
  s_mul_i32 s78, s73, 106496
  s_add_u32 s78, s78, 2768896
  s_lshl_b32 s77, s72, 10
  s_add_u32 s78, s78, s77
  buffer_load_dwordx4 v[20:23], v11, s[20:23], s78 offen
  s_add_u32 s78, s78, 43008
  buffer_load_dwordx4 v[24:27], v11, s[20:23], s78 offen
  s_add_u32 s78, s78, 43008
  s_cmp_lt_u32 s72, 20
  s_cbranch_scc0 L_hs15
  buffer_load_dwordx4 v[28:31], v11, s[20:23], s78 offen
L_hs15:
  s_waitcnt vmcnt(10)
  s_add_u32 s73, s75, 6
  s_cmp_ge_u32 s73, 13
  s_cselect_b32 s77, 13, 0
  s_sub_u32 s73, s73, s77
  s_mul_i32 s78, s73, 106496
  s_add_u32 s78, s78, 2768896
  s_lshl_b32 s77, s72, 10
  s_add_u32 s78, s78, s77
  buffer_load_dwordx4 v[20:23], v11, s[20:23], s78 offen
  s_add_u32 s78, s78, 43008
  buffer_load_dwordx4 v[24:27], v11, s[20:23], s78 offen
  s_add_u32 s78, s78, 43008
  s_cmp_lt_u32 s72, 20
  s_cbranch_scc0 L_hs16
  buffer_load_dwordx4 v[28:31], v11, s[20:23], s78 offen
L_hs16:
  s_waitcnt vmcnt(10)
  s_add_u32 s73, s75, 7
  s_cmp_ge_u32 s73, 13
  s_cselect_b32 s77, 13, 0
  s_sub_u32 s73, s73, s77
  s_mul_i32 s78, s73, 106496
  s_add_u32 s78, s78, 2768896
  s_lshl_b32 s77, s72, 10
  s_add_u32 s78, s78, s77
  buffer_load_dwordx4 v[20:23], v11, s[20:23], s78 offen
  s_add_u32 s78, s78, 43008
  buffer_load_dwordx4 v[24:27], v11, s[20:23], s78 offen
  s_add_u32 s78, s78, 43008
  s_cmp_lt_u32 s72, 20
  s_cbranch_scc0 L_hs17
  buffer_load_dwordx4 v[28:31], v11, s[20:23], s78 offen
L_hs17:
  s_waitcnt vmcnt(10)
  s_add_u32 s73, s75, 8
  s_cmp_ge_u32 s73, 13
  s_cselect_b32 s77, 13, 0
  s_sub_u32 s73, s73, s77
  s_mul_i32 s78, s73, 106496
  s_add_u32 s78, s78, 2768896
  s_lshl_b32 s77, s72, 10
  s_add_u32 s78, s78, s77
  buffer_load_dwordx4 v[20:23], v11, s[20:23], s78 offen
  s_add_u32 s78, s78, 43008
  buffer_load_dwordx4 v[24:27], v11, s[20:23], s78 offen
  s_add_u32 s78, s78, 43008
  s_cmp_lt_u32 s72, 20
  s_cbranch_scc0 L_hs18
  buffer_load_dwordx4 v[28:31], v11, s[20:23], s78 offen
L_hs18:
  s_waitcnt vmcnt(10)
  s_add_u32 s73, s75, 9
  s_cmp_ge_u32 s73, 13
  s_cselect_b32 s77, 13, 0
  s_sub_u32 s73, s73, s77
  s_mul_i32 s78, s73, 106496
  s_add_u32 s78, s78, 2768896
  s_lshl_b32 s77, s72, 10
  s_add_u32 s78, s78, s77
  buffer_load_dwordx4 v[20:23], v11, s[20:23], s78 offen
  s_add_u32 s78, s78, 43008
  buffer_load_dwordx4 v[24:27], v11, s[20:23], s78 offen
  s_add_u32 s78, s78, 43008
  s_cmp_lt_u32 s72, 20
  s_cbranch_scc0 L_hs19
  buffer_load_dwordx4 v[28:31], v11, s[20:23], s78 offen
L_hs19:
  s_waitcnt vmcnt(10)
  s_add_u32 s73, s75, 10
  s_cmp_ge_u32 s73, 13
  s_cselect_b32 s77, 13, 0
  s_sub_u32 s73, s73, s77
  s_mul_i32 s78, s73, 106496
  s_add_u32 s78, s78, 2768896
  s_lshl_b32 s77, s72, 10
  s_add_u32 s78, s78, s77
  buffer_load_dwordx4 v[20:23], v11, s[20:23], s78 offen
  s_add_u32 s78, s78, 43008
  buffer_load_dwordx4 v[24:27], v11, s[20:23], s78 offen
  s_add_u32 s78, s78, 43008
  s_cmp_lt_u32 s72, 20
  s_cbranch_scc0 L_hs20
  buffer_load_dwordx4 v[28:31], v11, s[20:23], s78 offen
L_hs20:
  s_waitcnt vmcnt(10)
  s_add_u32 s73, s75, 11
  s_cmp_ge_u32 s73, 13
  s_cselect_b32 s77, 13, 0
  s_sub_u32 s73, s73, s77
  s_mul_i32 s78, s73, 106496
  s_add_u32 s78, s78, 2768896
  s_lshl_b32 s77, s72, 10
  s_add_u32 s78, s78, s77
  buffer_load_dwordx4 v[20:23], v11, s[20:23], s78 offen
  s_add_u32 s78, s78, 43008
  buffer_load_dwordx4 v[24:27], v11, s[20:23], s78 offen
  s_add_u32 s78, s78, 43008
  s_cmp_lt_u32 s72, 20
  s_cbranch_scc0 L_hs21
  buffer_load_dwordx4 v[28:31], v11, s[20:23], s78 offen
L_hs21:
  s_waitcnt vmcnt(10)
  s_add_u32 s73, s75, 12
  s_cmp_ge_u32 s73, 13
  s_cselect_b32 s77, 13, 0
  s_sub_u32 s73, s73, s77
  s_mul_i32 s78, s73, 106496
  s_add_u32 s78, s78, 2768896
  s_lshl_b32 s77, s72, 10
  s_add_u32 s78, s78, s77
  buffer_load_dwordx4 v[20:23], v11, s[20:23], s78 offen
  s_add_u32 s78, s78, 43008
  buffer_load_dwordx4 v[24:27], v11, s[20:23], s78 offen
  s_add_u32 s78, s78, 43008
  s_cmp_lt_u32 s72, 20
  s_cbranch_scc0 L_hs22
  buffer_load_dwordx4 v[28:31], v11, s[20:23], s78 offen
L_hs22:
  s_waitcnt vmcnt(10)
  s_barrier
  s_lshl_b32 s78, s72, 10
  s_add_u32 s78, s78, 4992
  s_cmp_lt_u32 s72, 2
  s_cbranch_scc0 L_nb3
  buffer_load_dwordx4 v[44:47], v11, s[32:35], s78 offen
L_nb3:
  s_add_u32 s73, s75, 3
  s_cmp_ge_u32 s73, 13
  s_cselect_b32 s77, 13, 0
  s_sub_u32 s73, s73, s77
  s_mul_i32 s78, s73, 106496
  s_add_u32 s78, s78, 4153344
  s_lshl_b32 s77, s72, 10
  s_add_u32 s78, s78, s77
  buffer_load_dwordx4 v[20:23], v11, s[20:23], s78 offen
  s_add_u32 s78, s78, 43008
  buffer_load_dwordx4 v[24:27], v11, s[20:23], s78 offen
  s_add_u32 s78, s78, 43008
  s_cmp_lt_u32 s72, 20
  s_cbranch_scc0 L_hs23
  buffer_load_dwordx4 v[28:31], v11, s[20:23], s78 offen
L_hs23:
  s_waitcnt vmcnt(10)
  s_add_u32 s73, s75, 4
  s_cmp_ge_u32 s73, 13
  s_cselect_b32 s77, 13, 0
  s_sub_u32 s73, s73, s77
  s_mul_i32 s78, s73, 106496
  s_add_u32 s78, s78, 4153344
  s_lshl_b32 s77, s72, 10
  s_add_u32 s78, s78, s77
  buffer_load_dwordx4 v[20:23], v11, s[20:23], s78 offen
  s_add_u32 s78, s78, 43008
  buffer_load_dwordx4 v[24:27], v11, s[20:23], s78 offen
  s_add_u32 s78, s78, 43008
  s_cmp_lt_u32 s72, 20
  s_cbranch_scc0 L_hs24
  buffer_load_dwordx4 v[28:31], v11, s[20:23], s78 offen
L_hs24:
  s_waitcnt vmcnt(10)
  s_add_u32 s73, s75, 5
  s_cmp_ge_u32 s73, 13
  s_cselect_b32 s77, 13, 0
  s_sub_u32 s73, s73, s77
  s_mul_i32 s78, s73, 106496
  s_add_u32 s78, s78, 4153344
  s_lshl_b32 s77, s72, 10
  s_add_u32 s78, s78, s77
  buffer_load_dwordx4 v[20:23], v11, s[20:23], s78 offen
  s_add_u32 s78, s78, 43008
  buffer_load_dwordx4 v[24:27], v11, s[20:23], s78 offen
  s_add_u32 s78, s78, 43008
  s_cmp_lt_u32 s72, 20
  s_cbranch_scc0 L_hs25
  buffer_load_dwordx4 v[28:31], v11, s[20:23], s78 offen
L_hs25:
  s_waitcnt vmcnt(10)
  s_add_u32 s73, s75, 6
  s_cmp_ge_u32 s73, 13
  s_cselect_b32 s77, 13, 0
  s_sub_u32 s73, s73, s77
  s_mul_i32 s78, s73, 106496
  s_add_u32 s78, s78, 4153344
  s_lshl_b32 s77, s72, 10
  s_add_u32 s78, s78, s77
  buffer_load_dwordx4 v[20:23], v11, s[20:23], s78 offen
  s_add_u32 s78, s78, 43008
  buffer_load_dwordx4 v[24:27], v11, s[20:23], s78 offen
  s_add_u32 s78, s78, 43008
  s_cmp_lt_u32 s72, 20
  s_cbranch_scc0 L_hs26
  buffer_load_dwordx4 v[28:31], v11, s[20:23], s78 offen
L_hs26:
  s_waitcnt vmcnt(10)
  s_add_u32 s73, s75, 7
  s_cmp_ge_u32 s73, 13
  s_cselect_b32 s77, 13, 0
  s_sub_u32 s73, s73, s77
  s_mul_i32 s78, s73, 106496
  s_add_u32 s78, s78, 4153344
  s_lshl_b32 s77, s72, 10
  s_add_u32 s78, s78, s77
  buffer_load_dwordx4 v[20:23], v11, s[20:23], s78 offen
  s_add_u32 s78, s78, 43008
  buffer_load_dwordx4 v[24:27], v11, s[20:23], s78 offen
  s_add_u32 s78, s78, 43008
  s_cmp_lt_u32 s72, 20
  s_cbranch_scc0 L_hs27
  buffer_load_dwordx4 v[28:31], v11, s[20:23], s78 offen
L_hs27:
  s_waitcnt vmcnt(10)
  s_add_u32 s73, s75, 8
  s_cmp_ge_u32 s73, 13
  s_cselect_b32 s77, 13, 0
  s_sub_u32 s73, s73, s77
  s_mul_i32 s78, s73, 106496
  s_add_u32 s78, s78, 4153344
  s_lshl_b32 s77, s72, 10
  s_add_u32 s78, s78, s77
  buffer_load_dwordx4 v[20:23], v11, s[20:23], s78 offen
  s_add_u32 s78, s78, 43008
  buffer_load_dwordx4 v[24:27], v11, s[20:23], s78 offen
  s_add_u32 s78, s78, 43008
  s_cmp_lt_u32 s72, 20
  s_cbranch_scc0 L_hs28
  buffer_load_dwordx4 v[28:31], v11, s[20:23], s78 offen
L_hs28:
  s_waitcnt vmcnt(10)
  s_add_u32 s73, s75, 9
  s_cmp_ge_u32 s73, 13
  s_cselect_b32 s77, 13, 0
  s_sub_u32 s73, s73, s77
  s_mul_i32 s78, s73, 106496
  s_add_u32 s78, s78, 4153344
  s_lshl_b32 s77, s72, 10
  s_add_u32 s78, s78, s77
  buffer_load_dwordx4 v[20:23], v11, s[20:23], s78 offen
  s_add_u32 s78, s78, 43008
  buffer_load_dwordx4 v[24:27], v11, s[20:23], s78 offen
  s_add_u32 s78, s78, 43008
  s_cmp_lt_u32 s72, 20
  s_cbranch_scc0 L_hs29
  buffer_load_dwordx4 v[28:31], v11, s[20:23], s78 offen
L_hs29:
  s_waitcnt vmcnt(10)
  s_add_u32 s73, s75, 10
  s_cmp_ge_u32 s73, 13
  s_cselect_b32 s77, 13, 0
  s_sub_u32 s73, s73, s77
  s_mul_i32 s78, s73, 106496
  s_add_u32 s78, s78, 4153344
  s_lshl_b32 s77, s72, 10
  s_add_u32 s78, s78, s77
  buffer_load_dwordx4 v[20:23], v11, s[20:23], s78 offen
  s_add_u32 s78, s78, 43008
  buffer_load_dwordx4 v[24:27], v11, s[20:23], s78 offen
  s_add_u32 s78, s78, 43008
  s_cmp_lt_u32 s72, 20
  s_cbranch_scc0 L_hs30
  buffer_load_dwordx4 v[28:31], v11, s[20:23], s78 offen
L_hs30:
  s_waitcnt vmcnt(10)
  s_add_u32 s73, s75, 11
  s_cmp_ge_u32 s73, 13
  s_cselect_b32 s77, 13, 0
  s_sub_u32 s73, s73, s77
  s_mul_i32 s78, s73, 106496
  s_add_u32 s78, s78, 4153344
  s_lshl_b32 s77, s72, 10
  s_add_u32 s78, s78, s77
  buffer_load_dwordx4 v[20:23], v11, s[20:23], s78 offen
  s_add_u32 s78, s78, 43008
  buffer_load_dwordx4 v[24:27], v11, s[20:23], s78 offen
  s_add_u32 s78, s78, 43008
  s_cmp_lt_u32 s72, 20
  s_cbranch_scc0 L_hs31
  buffer_load_dwordx4 v[28:31], v11, s[20:23], s78 offen
L_hs31:
  s_waitcnt vmcnt(10)
  s_add_u32 s73, s75, 12
  s_cmp_ge_u32 s73, 13
  s_cselect_b32 s77, 13, 0
  s_sub_u32 s73, s73, s77
  s_mul_i32 s78, s73, 106496
  s_add_u32 s78, s78, 4153344
  s_lshl_b32 s77, s72, 10
  s_add_u32 s78, s78, s77
  buffer_load_dwordx4 v[20:23], v11, s[20:23], s78 offen
  s_add_u32 s78, s78, 43008
  buffer_load_dwordx4 v[24:27], v11, s[20:23], s78 offen
  s_add_u32 s78, s78, 43008
  s_cmp_lt_u32 s72, 20
  s_cbranch_scc0 L_hs32
  buffer_load_dwordx4 v[28:31], v11, s[20:23], s78 offen
L_hs32:
  s_waitcnt vmcnt(10)
  s_barrier
  s_lshl_b32 s78, s72, 10
  s_add_u32 s78, s78, 6656
  s_cmp_lt_u32 s72, 2
  s_cbranch_scc0 L_nb4
  buffer_load_dwordx4 v[44:47], v11, s[32:35], s78 offen
L_nb4:
  s_add_u32 s73, s75, 3
  s_cmp_ge_u32 s73, 13
  s_cselect_b32 s77, 13, 0
  s_sub_u32 s73, s73, s77
  s_mul_i32 s78, s73, 106496
  s_add_u32 s78, s78, 5537792
  s_lshl_b32 s77, s72, 10
  s_add_u32 s78, s78, s77
  buffer_load_dwordx4 v[20:23], v11, s[20:23], s78 offen
  s_add_u32 s78, s78, 43008
  buffer_load_dwordx4 v[24:27], v11, s[20:23], s78 offen
  s_add_u32 s78, s78, 43008
  s_cmp_lt_u32 s72, 20
  s_cbranch_scc0 L_hs33
  buffer_load_dwordx4 v[28:31], v11, s[20:23], s78 offen
L_hs33:
  s_waitcnt vmcnt(10)
  s_add_u32 s73, s75, 4
  s_cmp_ge_u32 s73, 13
  s_cselect_b32 s77, 13, 0
  s_sub_u32 s73, s73, s77
  s_mul_i32 s78, s73, 106496
  s_add_u32 s78, s78, 5537792
  s_lshl_b32 s77, s72, 10
  s_add_u32 s78, s78, s77
  buffer_load_dwordx4 v[20:23], v11, s[20:23], s78 offen
  s_add_u32 s78, s78, 43008
  buffer_load_dwordx4 v[24:27], v11, s[20:23], s78 offen
  s_add_u32 s78, s78, 43008
  s_cmp_lt_u32 s72, 20
  s_cbranch_scc0 L_hs34
  buffer_load_dwordx4 v[28:31], v11, s[20:23], s78 offen
L_hs34:
  s_waitcnt vmcnt(10)
  s_add_u32 s73, s75, 5
  s_cmp_ge_u32 s73, 13
  s_cselect_b32 s77, 13, 0
  s_sub_u32 s73, s73, s77
  s_mul_i32 s78, s73, 106496
  s_add_u32 s78, s78, 5537792
  s_lshl_b32 s77, s72, 10
  s_add_u32 s78, s78, s77
  buffer_load_dwordx4 v[20:23], v11, s[20:23], s78 offen
  s_add_u32 s78, s78, 43008
  buffer_load_dwordx4 v[24:27], v11, s[20:23], s78 offen
  s_add_u32 s78, s78, 43008
  s_cmp_lt_u32 s72, 20
  s_cbranch_scc0 L_hs35
  buffer_load_dwordx4 v[28:31], v11, s[20:23], s78 offen
L_hs35:
  s_waitcnt vmcnt(10)
  s_add_u32 s73, s75, 6
  s_cmp_ge_u32 s73, 13
  s_cselect_b32 s77, 13, 0
  s_sub_u32 s73, s73, s77
  s_mul_i32 s78, s73, 106496
  s_add_u32 s78, s78, 5537792
  s_lshl_b32 s77, s72, 10
  s_add_u32 s78, s78, s77
  buffer_load_dwordx4 v[20:23], v11, s[20:23], s78 offen
  s_add_u32 s78, s78, 43008
  buffer_load_dwordx4 v[24:27], v11, s[20:23], s78 offen
  s_add_u32 s78, s78, 43008
  s_cmp_lt_u32 s72, 20
  s_cbranch_scc0 L_hs36
  buffer_load_dwordx4 v[28:31], v11, s[20:23], s78 offen
L_hs36:
  s_waitcnt vmcnt(10)
  s_add_u32 s73, s75, 7
  s_cmp_ge_u32 s73, 13
  s_cselect_b32 s77, 13, 0
  s_sub_u32 s73, s73, s77
  s_mul_i32 s78, s73, 106496
  s_add_u32 s78, s78, 5537792
  s_lshl_b32 s77, s72, 10
  s_add_u32 s78, s78, s77
  buffer_load_dwordx4 v[20:23], v11, s[20:23], s78 offen
  s_add_u32 s78, s78, 43008
  buffer_load_dwordx4 v[24:27], v11, s[20:23], s78 offen
  s_add_u32 s78, s78, 43008
  s_cmp_lt_u32 s72, 20
  s_cbranch_scc0 L_hs37
  buffer_load_dwordx4 v[28:31], v11, s[20:23], s78 offen
L_hs37:
  s_waitcnt vmcnt(10)
  s_add_u32 s73, s75, 8
  s_cmp_ge_u32 s73, 13
  s_cselect_b32 s77, 13, 0
  s_sub_u32 s73, s73, s77
  s_mul_i32 s78, s73, 106496
  s_add_u32 s78, s78, 5537792
  s_lshl_b32 s77, s72, 10
  s_add_u32 s78, s78, s77
  buffer_load_dwordx4 v[20:23], v11, s[20:23], s78 offen
  s_add_u32 s78, s78, 43008
  buffer_load_dwordx4 v[24:27], v11, s[20:23], s78 offen
  s_add_u32 s78, s78, 43008
  s_cmp_lt_u32 s72, 20
  s_cbranch_scc0 L_hs38
  buffer_load_dwordx4 v[28:31], v11, s[20:23], s78 offen
L_hs38:
  s_waitcnt vmcnt(10)
  s_add_u32 s73, s75, 9
  s_cmp_ge_u32 s73, 13
  s_cselect_b32 s77, 13, 0
  s_sub_u32 s73, s73, s77
  s_mul_i32 s78, s73, 106496
  s_add_u32 s78, s78, 5537792
  s_lshl_b32 s77, s72, 10
  s_add_u32 s78, s78, s77
  buffer_load_dwordx4 v[20:23], v11, s[20:23], s78 offen
  s_add_u32 s78, s78, 43008
  buffer_load_dwordx4 v[24:27], v11, s[20:23], s78 offen
  s_add_u32 s78, s78, 43008
  s_cmp_lt_u32 s72, 20
  s_cbranch_scc0 L_hs39
  buffer_load_dwordx4 v[28:31], v11, s[20:23], s78 offen
L_hs39:
  s_waitcnt vmcnt(10)
  s_add_u32 s73, s75, 10
  s_cmp_ge_u32 s73, 13
  s_cselect_b32 s77, 13, 0
  s_sub_u32 s73, s73, s77
  s_mul_i32 s78, s73, 106496
  s_add_u32 s78, s78, 5537792
  s_lshl_b32 s77, s72, 10
  s_add_u32 s78, s78, s77
  buffer_load_dwordx4 v[20:23], v11, s[20:23], s78 offen
  s_add_u32 s78, s78, 43008
  buffer_load_dwordx4 v[24:27], v11, s[20:23], s78 offen
  s_add_u32 s78, s78, 43008
  s_cmp_lt_u32 s72, 20
  s_cbranch_scc0 L_hs40
  buffer_load_dwordx4 v[28:31], v11, s[20:23], s78 offen
L_hs40:
  s_waitcnt vmcnt(10)
  s_add_u32 s73, s75, 11
  s_cmp_ge_u32 s73, 13
  s_cselect_b32 s77, 13, 0
  s_sub_u32 s73, s73, s77
  s_mul_i32 s78, s73, 106496
  s_add_u32 s78, s78, 5537792
  s_lshl_b32 s77, s72, 10
  s_add_u32 s78, s78, s77
  buffer_load_dwordx4 v[20:23], v11, s[20:23], s78 offen
  s_add_u32 s78, s78, 43008
  buffer_load_dwordx4 v[24:27], v11, s[20:23], s78 offen
  s_add_u32 s78, s78, 43008
  s_cmp_lt_u32 s72, 20
  s_cbranch_scc0 L_hs41
  buffer_load_dwordx4 v[28:31], v11, s[20:23], s78 offen
L_hs41:
  s_waitcnt vmcnt(10)
  s_add_u32 s73, s75, 12
  s_cmp_ge_u32 s73, 13
  s_cselect_b32 s77, 13, 0
  s_sub_u32 s73, s73, s77
  s_mul_i32 s78, s73, 106496
  s_add_u32 s78, s78, 5537792
  s_lshl_b32 s77, s72, 10
  s_add_u32 s78, s78, s77
  buffer_load_dwordx4 v[20:23], v11, s[20:23], s78 offen
  s_add_u32 s78, s78, 43008
  buffer_load_dwordx4 v[24:27], v11, s[20:23], s78 offen
  s_add_u32 s78, s78, 43008
  s_cmp_lt_u32 s72, 20
  s_cbranch_scc0 L_hs42
  buffer_load_dwordx4 v[28:31], v11, s[20:23], s78 offen
L_hs42:
  s_waitcnt vmcnt(10)
  s_barrier
  s_lshl_b32 s78, s72, 10
  s_add_u32 s78, s78, 8320
  s_cmp_lt_u32 s72, 2
  s_cbranch_scc0 L_nb5
  buffer_load_dwordx4 v[44:47], v11, s[32:35], s78 offen
L_nb5:
  s_add_u32 s73, s75, 3
  s_cmp_ge_u32 s73, 13
  s_cselect_b32 s77, 13, 0
  s_sub_u32 s73, s73, s77
  s_mul_i32 s78, s73, 106496
  s_add_u32 s78, s78, 6922240
  s_lshl_b32 s77, s72, 10
  s_add_u32 s78, s78, s77
  buffer_load_dwordx4 v[20:23], v11, s[20:23], s78 offen
  s_add_u32 s78, s78, 43008
  buffer_load_dwordx4 v[24:27], v11, s[20:23], s78 offen
  s_add_u32 s78, s78, 43008
  s_cmp_lt_u32 s72, 20
  s_cbranch_scc0 L_hs43
  buffer_load_dwordx4 v[28:31], v11, s[20:23], s78 offen
L_hs43:
  s_waitcnt vmcnt(10)
  s_add_u32 s73, s75, 4
  s_cmp_ge_u32 s73, 13
  s_cselect_b32 s77, 13, 0
  s_sub_u32 s73, s73, s77
  s_mul_i32 s78, s73, 106496
  s_add_u32 s78, s78, 6922240
  s_lshl_b32 s77, s72, 10
  s_add_u32 s78, s78, s77
  buffer_load_dwordx4 v[20:23], v11, s[20:23], s78 offen
  s_add_u32 s78, s78, 43008
  buffer_load_dwordx4 v[24:27], v11, s[20:23], s78 offen
  s_add_u32 s78, s78, 43008
  s_cmp_lt_u32 s72, 20
  s_cbranch_scc0 L_hs44
  buffer_load_dwordx4 v[28:31], v11, s[20:23], s78 offen
L_hs44:
  s_waitcnt vmcnt(10)
  s_add_u32 s73, s75, 5
  s_cmp_ge_u32 s73, 13
  s_cselect_b32 s77, 13, 0
  s_sub_u32 s73, s73, s77
  s_mul_i32 s78, s73, 106496
  s_add_u32 s78, s78, 6922240
  s_lshl_b32 s77, s72, 10
  s_add_u32 s78, s78, s77
  buffer_load_dwordx4 v[20:23], v11, s[20:23], s78 offen
  s_add_u32 s78, s78, 43008
  buffer_load_dwordx4 v[24:27], v11, s[20:23], s78 offen
  s_add_u32 s78, s78, 43008
  s_cmp_lt_u32 s72, 20
  s_cbranch_scc0 L_hs45
  buffer_load_dwordx4 v[28:31], v11, s[20:23], s78 offen
L_hs45:
  s_waitcnt vmcnt(10)
  s_add_u32 s73, s75, 6
  s_cmp_ge_u32 s73, 13
  s_cselect_b32 s77, 13, 0
  s_sub_u32 s73, s73, s77
  s_mul_i32 s78, s73, 106496
  s_add_u32 s78, s78, 6922240
  s_lshl_b32 s77, s72, 10
  s_add_u32 s78, s78, s77
  buffer_load_dwordx4 v[20:23], v11, s[20:23], s78 offen
  s_add_u32 s78, s78, 43008
  buffer_load_dwordx4 v[24:27], v11, s[20:23], s78 offen
  s_add_u32 s78, s78, 43008
  s_cmp_lt_u32 s72, 20
  s_cbranch_scc0 L_hs46
  buffer_load_dwordx4 v[28:31], v11, s[20:23], s78 offen
L_hs46:
  s_waitcnt vmcnt(10)
  s_add_u32 s73, s75, 7
  s_cmp_ge_u32 s73, 13
  s_cselect_b32 s77, 13, 0
  s_sub_u32 s73, s73, s77
  s_mul_i32 s78, s73, 106496
  s_add_u32 s78, s78, 6922240
  s_lshl_b32 s77, s72, 10
  s_add_u32 s78, s78, s77
  buffer_load_dwordx4 v[20:23], v11, s[20:23], s78 offen
  s_add_u32 s78, s78, 43008
  buffer_load_dwordx4 v[24:27], v11, s[20:23], s78 offen
  s_add_u32 s78, s78, 43008
  s_cmp_lt_u32 s72, 20
  s_cbranch_scc0 L_hs47
  buffer_load_dwordx4 v[28:31], v11, s[20:23], s78 offen
L_hs47:
  s_waitcnt vmcnt(10)
  s_add_u32 s73, s75, 8
  s_cmp_ge_u32 s73, 13
  s_cselect_b32 s77, 13, 0
  s_sub_u32 s73, s73, s77
  s_mul_i32 s78, s73, 106496
  s_add_u32 s78, s78, 6922240
  s_lshl_b32 s77, s72, 10
  s_add_u32 s78, s78, s77
  buffer_load_dwordx4 v[20:23], v11, s[20:23], s78 offen
  s_add_u32 s78, s78, 43008
  buffer_load_dwordx4 v[24:27], v11, s[20:23], s78 offen
  s_add_u32 s78, s78, 43008
  s_cmp_lt_u32 s72, 20
  s_cbranch_scc0 L_hs48
  buffer_load_dwordx4 v[28:31], v11, s[20:23], s78 offen
L_hs48:
  s_waitcnt vmcnt(10)
  s_add_u32 s73, s75, 9
  s_cmp_ge_u32 s73, 13
  s_cselect_b32 s77, 13, 0
  s_sub_u32 s73, s73, s77
  s_mul_i32 s78, s73, 106496
  s_add_u32 s78, s78, 6922240
  s_lshl_b32 s77, s72, 10
  s_add_u32 s78, s78, s77
  buffer_load_dwordx4 v[20:23], v11, s[20:23], s78 offen
  s_add_u32 s78, s78, 43008
  buffer_load_dwordx4 v[24:27], v11, s[20:23], s78 offen
  s_add_u32 s78, s78, 43008
  s_cmp_lt_u32 s72, 20
  s_cbranch_scc0 L_hs49
  buffer_load_dwordx4 v[28:31], v11, s[20:23], s78 offen
L_hs49:
  s_waitcnt vmcnt(10)
  s_add_u32 s73, s75, 10
  s_cmp_ge_u32 s73, 13
  s_cselect_b32 s77, 13, 0
  s_sub_u32 s73, s73, s77
  s_mul_i32 s78, s73, 106496
  s_add_u32 s78, s78, 6922240
  s_lshl_b32 s77, s72, 10
  s_add_u32 s78, s78, s77
  buffer_load_dwordx4 v[20:23], v11, s[20:23], s78 offen
  s_add_u32 s78, s78, 43008
  buffer_load_dwordx4 v[24:27], v11, s[20:23], s78 offen
  s_add_u32 s78, s78, 43008
  s_cmp_lt_u32 s72, 20
  s_cbranch_scc0 L_hs50
  buffer_load_dwordx4 v[28:31], v11, s[20:23], s78 offen
L_hs50:
  s_waitcnt vmcnt(10)
  s_add_u32 s73, s75, 11
  s_cmp_ge_u32 s73, 13
  s_cselect_b32 s77, 13, 0
  s_sub_u32 s73, s73, s77
  s_mul_i32 s78, s73, 106496
  s_add_u32 s78, s78, 6922240
  s_lshl_b32 s77, s72, 10
  s_add_u32 s78, s78, s77
  buffer_load_dwordx4 v[20:23], v11, s[20:23], s78 offen
  s_add_u32 s78, s78, 43008
  buffer_load_dwordx4 v[24:27], v11, s[20:23], s78 offen
  s_add_u32 s78, s78, 43008
  s_cmp_lt_u32 s72, 20
  s_cbranch_scc0 L_hs51
  buffer_load_dwordx4 v[28:31], v11, s[20:23], s78 offen
L_hs51:
  s_waitcnt vmcnt(10)
  s_add_u32 s73, s75, 12
  s_cmp_ge_u32 s73, 13
  s_cselect_b32 s77, 13, 0
  s_sub_u32 s73, s73, s77
  s_mul_i32 s78, s73, 106496
  s_add_u32 s78, s78, 6922240
  s_lshl_b32 s77, s72, 10
  s_add_u32 s78, s78, s77
  buffer_load_dwordx4 v[20:23], v11, s[20:23], s78 offen
  s_add_u32 s78, s78, 43008
  buffer_load_dwordx4 v[24:27], v11, s[20:23], s78 offen
  s_add_u32 s78, s78, 43008
  s_cmp_lt_u32 s72, 20
  s_cbranch_scc0 L_hs52
  buffer_load_dwordx4 v[28:31], v11, s[20:23], s78 offen
L_hs52:
  s_waitcnt vmcnt(10)
  s_branch L_hend
L_pacer:
  s_mov_b32 s57, 0
L_ha:
  buffer_load_ubyte v16, v14, s[36:39], 0 offen sc1
  s_waitcnt vmcnt(0)
  v_cmp_eq_u32 vcc, 0, v16
  s_add_u32 s57, s57, 1
  s_cmp_gt_u32 s57, 400
  s_cbranch_scc1 L_hax
  s_cbranch_vccnz L_ha
L_hax:
  s_mov_b32 s57, 0
L_hp2:
  buffer_load_ubyte v16, v15, s[24:27], 0 offen sc1
  s_waitcnt vmcnt(0)
  v_cmp_gt_u32 vcc, 1, v16
  s_add_u32 s57, s57, 1
  s_cmp_gt_u32 s57, 400
  s_cbranch_scc1 L_hpx2
  s_cbranch_vccnz L_hp2
L_hpx2:
  s_barrier
  s_mov_b32 s57, 0
L_hp3:
  buffer_load_ubyte v16, v15, s[24:27], 0 offen sc1
  s_waitcnt vmcnt(0)
  v_cmp_gt_u32 vcc, 2, v16
  s_add_u32 s57, s57, 1
  s_cmp_gt_u32 s57, 400
  s_cbranch_scc1 L_hpx3
  s_cbranch_vccnz L_hp3
L_hpx3:
  s_barrier
  s_mov_b32 s57, 0
L_hp4:
  buffer_load_ubyte v16, v15, s[24:27], 0 offen sc1
  s_waitcnt vmcnt(0)
  v_cmp_gt_u32 vcc, 3, v16
  s_add_u32 s57, s57, 1
  s_cmp_gt_u32 s57, 400
  s_cbranch_scc1 L_hpx4
  s_cbranch_vccnz L_hp4
L_hpx4:
  s_barrier
  s_mov_b32 s57, 0
L_hp5:
  buffer_load_ubyte v16, v15, s[24:27], 0 offen sc1
  s_waitcnt vmcnt(0)
  v_cmp_gt_u32 vcc, 4, v16
  s_add_u32 s57, s57, 1
  s_cmp_gt_u32 s57, 400
  s_cbranch_scc1 L_hpx5
  s_cbranch_vccnz L_hp5
L_hpx5:
  s_barrier
  s_branch L_done
L_hend:
  s_waitcnt vmcnt(0)
L_done:
  s_endpgm
.p2align 4
L_codeend:
.section .rodata,"a"
.p2align 6
.amdhsa_kernel standalone__dcn_v2_cross__recsys_kernel
  .amdhsa_next_free_vgpr 200
  .amdhsa_next_free_sgpr 102
  .amdhsa_accum_offset 200
  .amdhsa_group_segment_fixed_size 0
  .amdhsa_kernarg_size 48
  .amdhsa_user_sgpr_count 2
  .amdhsa_user_sgpr_kernarg_segment_ptr 1
  .amdhsa_system_sgpr_workgroup_id_x 1
  .amdhsa_float_denorm_mode_32 3
.end_amdhsa_kernel
```
